```python
import torch

def _softmax(x, axis=-1):
    return torch.softmax(x, dim=axis)
def _gelu(x):
    return torch.nn.functional.gelu(x, approximate="tanh")
def _silu(x):
    return torch.nn.functional.silu(x)
def _sigmoid(x):
    return torch.sigmoid(x)
def _layernorm(x, axis=-1, eps=1e-5):
    m = x.mean(dim=axis, keepdim=True)
    v = x.var(dim=axis, keepdim=True, unbiased=False)
    return (x - m) / torch.sqrt(v + eps)
def _scatter_add(tgt, idx, src, axis=0):
    return tgt.clone().index_add_(axis, idx, src)
def _segment_sum(src, seg, n):
    out = torch.zeros((n,) + src.shape[1:], dtype=src.dtype)
    return out.index_add_(0, seg, src)
def _pad(x, pw):
    flat = tuple(v for pair in reversed(pw) for v in pair)
    return torch.nn.functional.pad(x, flat)

kernel_name = 'sequential_preLN__mha_block_cached__dense_activation_silu__decode'

def setup_inputs():

    _w = (lambda a: (lambda t: t.to(torch.bfloat16) if t.is_floating_point() else t)(torch.as_tensor(a)))
    def _A_setup():
        B, Sq, D = 2, 1, 512
        H, Sk, Dh = 32, 4096, 128
        return {
            "x": _w((lambda *s: torch.randn(*s, dtype=torch.bfloat16) * 0.1)(B, Sq, D)),
            "k_cache": _w((lambda *s: torch.randn(*s, dtype=torch.bfloat16) * 1.6)(B, H, Sk, Dh)),
            "v_cache": _w((lambda *s: torch.randn(*s, dtype=torch.bfloat16) * 1.6)(B, H, Sk, Dh)),
            "wq": _w((lambda *s: torch.randn(*s, dtype=torch.bfloat16) * 1.6)(D, H * Dh) * (D ** -0.5)),
            "wo": _w((lambda *s: torch.randn(*s, dtype=torch.bfloat16) * 1.6)(H * Dh, D) * ((H * Dh) ** -0.5)),
        }
    _A_in = _A_setup()

    def _B_setup():
        B, S, D, F = 2, 1, 512, 1376
        return {
            "x": _w((lambda *s: torch.randn(*s, dtype=torch.bfloat16) * 0.1)(B, S, D)),
            "w1": _w((lambda *s: torch.randn(*s, dtype=torch.bfloat16) * 3.2)(D, F) * (D ** -0.5)),
            "w2": _w((lambda *s: torch.randn(*s, dtype=torch.bfloat16) * 3.2)(F, D) * (F ** -0.5)),
        }
    _B_in = _B_setup()

    return {
        "A_x": _A_in["x"],
        "A_k_cache": _A_in["k_cache"],
        "A_v_cache": _A_in["v_cache"],
        "A_wq": _A_in["wq"],
        "A_wo": _A_in["wo"],
        "B_x": _B_in["x"],
        "B_w1": _B_in["w1"],
        "B_w2": _B_in["w2"],
    }

def reference(A_x, A_k_cache, A_v_cache, A_wq, A_wo, B_x, B_w1, B_w2):
    def _A_ref(x, k_cache, v_cache, wq, wo):
        B, Sq, D = x.shape
        H, Dh = 32, 128
        q = (lambda x, *d: x.permute(*d))((x @ wq).reshape(B, Sq, H, Dh), 0, 2, 1, 3)
        scores = torch.einsum("bhqd,bhkd->bhqk", q, k_cache) * (Dh ** -0.5)
        p = _softmax(scores, axis=-1)
        o = torch.einsum("bhqk,bhkd->bhqd", p, v_cache)
        return (lambda x, *d: x.permute(*d))(o, 0, 2, 1, 3).reshape(B, Sq, H * Dh) @ wo

    def _B_ref(x, w1, w2):
        h = torch.einsum("bsd,df->bsf", x, w1)
        h = _silu(h)
        out = torch.einsum("bsf,fd->bsd", h, w2)
        return out

    x = A_x
    h = x + _A_ref(_layernorm(x, axis=-1), A_k_cache, A_v_cache, A_wq, A_wo)
    h2 = h + _B_ref(_layernorm(h, axis=-1), B_w1, B_w2)
    return h2
```

```asm
; @launch grid=(256,1,1) block=(320,1,1) lds=154368
.amdgcn_target "amdgcn-amd-amdhsa--gfx950"
.text
.globl sequential_preLN__mha_block_cached__dense_activation_silu__decode_kernel
.p2align 8
.type sequential_preLN__mha_block_cached__dense_activation_silu__decode_kernel,@function
sequential_preLN__mha_block_cached__dense_activation_silu__decode_kernel:
s_load_dwordx16 s[4:19], s[0:1], 0
s_load_dwordx4 s[20:23], s[0:1], 64
s_load_dwordx2 s[24:25], s[0:1], 80
s_cmp_ge_u32 s2, 256
s_cbranch_scc1 L_end
v_lshrrev_b32 v2, 6, v0
v_and_b32 v0, 63, v0
v_readfirstlane_b32 s3, v2
v_lshlrev_b32 v1, 4, v0
s_and_b32 s68, s2, 7
s_lshr_b32 s73, s2, 3
s_and_b32 s74, s73, 3
s_lshl_b32 s74, s74, 3
s_add_u32 s68, s68, s74
s_lshr_b32 s82, s73, 2
s_lshr_b32 s69, s82, 2
s_and_b32 s70, s82, 3
v_and_b32 v6, 15, v0
v_lshrrev_b32 v7, 4, v0
s_cmp_eq_u32 s3, 4
s_cbranch_scc1 L_helper
s_lshl_b32 s71, s69, 5
s_add_u32 s71, s71, s68
s_lshl_b32 s71, s71, 20
s_lshl_b32 s73, s70, 18
s_add_u32 s71, s71, s73
s_lshl_b32 s73, s3, 10
s_add_u32 s71, s71, s73
s_lshr_b32 s72, s2, 3
s_mul_i32 s72, s72, 4096
s_and_b32 s72, s72, 0x3ffff
s_waitcnt lgkmcnt(0)
s_mov_b32 s28, s6
s_mov_b32 s29, s7
s_mov_b32 s30, 67108864
s_mov_b32 s31, 0x20000
s_lshl_b32 s90, s3, 15
s_add_u32 s90, s90, 23296
v_add_u32 v52, s90, v1
s_add_u32 s73, s72, 0
s_and_b32 s73, s73, 0x3ffff
s_add_u32 s73, s73, s71
buffer_load_dwordx4 v[64:67], v1, s[28:31], s73 offen nt
s_add_u32 s73, s72, 4096
s_and_b32 s73, s73, 0x3ffff
s_add_u32 s73, s73, s71
buffer_load_dwordx4 v[68:71], v1, s[28:31], s73 offen nt
s_add_u32 s73, s72, 8192
s_and_b32 s73, s73, 0x3ffff
s_add_u32 s73, s73, s71
buffer_load_dwordx4 v[72:75], v1, s[28:31], s73 offen nt
s_add_u32 s73, s72, 12288
s_and_b32 s73, s73, 0x3ffff
s_add_u32 s73, s73, s71
buffer_load_dwordx4 v[76:79], v1, s[28:31], s73 offen nt
s_add_u32 s73, s72, 16384
s_and_b32 s73, s73, 0x3ffff
s_add_u32 s73, s73, s71
buffer_load_dwordx4 v[80:83], v1, s[28:31], s73 offen nt
s_add_u32 s73, s72, 20480
s_and_b32 s73, s73, 0x3ffff
s_add_u32 s73, s73, s71
buffer_load_dwordx4 v[84:87], v1, s[28:31], s73 offen nt
s_add_u32 s73, s72, 24576
s_and_b32 s73, s73, 0x3ffff
s_add_u32 s73, s73, s71
buffer_load_dwordx4 v[88:91], v1, s[28:31], s73 offen nt
s_add_u32 s73, s72, 28672
s_and_b32 s73, s73, 0x3ffff
s_add_u32 s73, s73, s71
buffer_load_dwordx4 v[92:95], v1, s[28:31], s73 offen nt
s_mov_b32 s32, s8
s_mov_b32 s33, s9
s_mov_b32 s34, 67108864
s_mov_b32 s35, 0x20000
s_mov_b32 s56, s24
s_mov_b32 s57, s25
s_mov_b32 s58, 268435456
s_mov_b32 s59, 0x20000
s_barrier
s_mov_b32 s84, 0xffff0000
s_mov_b32 s85, 0
s_mov_b32 s86, 0
s_mov_b32 s87, 0xffff
s_mov_b32 s88, 0
s_mov_b32 s89, 0xffff0000
s_mov_b32 s76, 0xaaaaaaaa
s_mov_b32 s77, 0xaaaaaaaa
s_mov_b32 s78, 0xcccccccc
s_mov_b32 s79, 0xcccccccc
s_add_u32 s73, s72, 32768
s_and_b32 s73, s73, 0x3ffff
s_add_u32 s73, s73, s71
buffer_load_dwordx4 v[96:99], v1, s[28:31], s73 offen nt
s_add_u32 s73, s72, 36864
s_and_b32 s73, s73, 0x3ffff
s_add_u32 s73, s73, s71
buffer_load_dwordx4 v[100:103], v1, s[28:31], s73 offen nt
s_add_u32 s73, s72, 40960
s_and_b32 s73, s73, 0x3ffff
s_add_u32 s73, s73, s71
buffer_load_dwordx4 v[104:107], v1, s[28:31], s73 offen nt
s_add_u32 s73, s72, 45056
s_and_b32 s73, s73, 0x3ffff
s_add_u32 s73, s73, s71
buffer_load_dwordx4 v[108:111], v1, s[28:31], s73 offen nt
s_waitcnt vmcnt(11)
s_add_u32 s73, s72, 49152
s_and_b32 s73, s73, 0x3ffff
s_add_u32 s73, s73, s71
buffer_load_dwordx4 v[112:115], v1, s[28:31], s73 offen nt
s_waitcnt vmcnt(11)
s_add_u32 s73, s72, 53248
s_and_b32 s73, s73, 0x3ffff
s_add_u32 s73, s73, s71
buffer_load_dwordx4 v[116:119], v1, s[28:31], s73 offen nt
s_waitcnt vmcnt(11)
s_add_u32 s73, s72, 57344
s_and_b32 s73, s73, 0x3ffff
s_add_u32 s73, s73, s71
buffer_load_dwordx4 v[120:123], v1, s[28:31], s73 offen nt
s_waitcnt vmcnt(11)
s_add_u32 s73, s72, 61440
s_and_b32 s73, s73, 0x3ffff
s_add_u32 s73, s73, s71
buffer_load_dwordx4 v[124:127], v1, s[28:31], s73 offen nt
s_waitcnt vmcnt(11)
s_add_u32 s73, s72, 65536
s_and_b32 s73, s73, 0x3ffff
s_add_u32 s73, s73, s71
buffer_load_dwordx4 v[128:131], v1, s[28:31], s73 offen nt
s_waitcnt vmcnt(11)
s_add_u32 s73, s72, 69632
s_and_b32 s73, s73, 0x3ffff
s_add_u32 s73, s73, s71
buffer_load_dwordx4 v[132:135], v1, s[28:31], s73 offen nt
s_waitcnt vmcnt(11)
s_add_u32 s73, s72, 73728
s_and_b32 s73, s73, 0x3ffff
s_add_u32 s73, s73, s71
buffer_load_dwordx4 v[136:139], v1, s[28:31], s73 offen nt
s_waitcnt vmcnt(11)
s_add_u32 s73, s72, 77824
s_and_b32 s73, s73, 0x3ffff
s_add_u32 s73, s73, s71
buffer_load_dwordx4 v[140:143], v1, s[28:31], s73 offen nt
s_waitcnt vmcnt(11)
s_add_u32 s73, s72, 81920
s_and_b32 s73, s73, 0x3ffff
s_add_u32 s73, s73, s71
buffer_load_dwordx4 v[144:147], v1, s[28:31], s73 offen nt
s_waitcnt vmcnt(11)
s_add_u32 s73, s72, 86016
s_and_b32 s73, s73, 0x3ffff
s_add_u32 s73, s73, s71
buffer_load_dwordx4 v[148:151], v1, s[28:31], s73 offen nt
s_waitcnt vmcnt(11)
s_add_u32 s73, s72, 90112
s_and_b32 s73, s73, 0x3ffff
s_add_u32 s73, s73, s71
buffer_load_dwordx4 v[152:155], v1, s[28:31], s73 offen nt
s_waitcnt vmcnt(11)
s_add_u32 s73, s72, 94208
s_and_b32 s73, s73, 0x3ffff
s_add_u32 s73, s73, s71
buffer_load_dwordx4 v[156:159], v1, s[28:31], s73 offen nt
s_waitcnt vmcnt(11)
s_add_u32 s73, s72, 98304
s_and_b32 s73, s73, 0x3ffff
s_add_u32 s73, s73, s71
buffer_load_dwordx4 v[160:163], v1, s[28:31], s73 offen nt
s_waitcnt vmcnt(11)
s_add_u32 s73, s72, 102400
s_and_b32 s73, s73, 0x3ffff
s_add_u32 s73, s73, s71
buffer_load_dwordx4 v[164:167], v1, s[28:31], s73 offen nt
s_waitcnt vmcnt(11)
s_add_u32 s73, s72, 106496
s_and_b32 s73, s73, 0x3ffff
s_add_u32 s73, s73, s71
buffer_load_dwordx4 v[168:171], v1, s[28:31], s73 offen nt
s_waitcnt vmcnt(11)
s_add_u32 s73, s72, 110592
s_and_b32 s73, s73, 0x3ffff
s_add_u32 s73, s73, s71
buffer_load_dwordx4 v[172:175], v1, s[28:31], s73 offen nt
s_waitcnt vmcnt(11)
s_add_u32 s73, s72, 114688
s_and_b32 s73, s73, 0x3ffff
s_add_u32 s73, s73, s71
buffer_load_dwordx4 v[176:179], v1, s[28:31], s73 offen nt
s_waitcnt vmcnt(11)
s_add_u32 s73, s72, 118784
s_and_b32 s73, s73, 0x3ffff
s_add_u32 s73, s73, s71
buffer_load_dwordx4 v[180:183], v1, s[28:31], s73 offen nt
s_waitcnt vmcnt(11)
s_add_u32 s73, s72, 122880
s_and_b32 s73, s73, 0x3ffff
s_add_u32 s73, s73, s71
buffer_load_dwordx4 v[184:187], v1, s[28:31], s73 offen nt
s_waitcnt vmcnt(11)
s_add_u32 s73, s72, 126976
s_and_b32 s73, s73, 0x3ffff
s_add_u32 s73, s73, s71
buffer_load_dwordx4 v[188:191], v1, s[28:31], s73 offen nt
s_waitcnt vmcnt(11)
s_add_u32 s73, s72, 131072
s_and_b32 s73, s73, 0x3ffff
s_add_u32 s73, s73, s71
buffer_load_dwordx4 v[192:195], v1, s[28:31], s73 offen nt
s_waitcnt vmcnt(11)
s_add_u32 s73, s72, 135168
s_and_b32 s73, s73, 0x3ffff
s_add_u32 s73, s73, s71
buffer_load_dwordx4 v[196:199], v1, s[28:31], s73 offen nt
s_waitcnt vmcnt(11)
s_add_u32 s73, s72, 139264
s_and_b32 s73, s73, 0x3ffff
s_add_u32 s73, s73, s71
buffer_load_dwordx4 v[200:203], v1, s[28:31], s73 offen nt
s_waitcnt vmcnt(11)
s_add_u32 s73, s72, 143360
s_and_b32 s73, s73, 0x3ffff
s_add_u32 s73, s73, s71
buffer_load_dwordx4 v[204:207], v1, s[28:31], s73 offen nt
s_waitcnt vmcnt(11)
s_add_u32 s73, s72, 147456
s_and_b32 s73, s73, 0x3ffff
s_add_u32 s73, s73, s71
buffer_load_dwordx4 v[208:211], v1, s[28:31], s73 offen nt
s_waitcnt vmcnt(11)
s_add_u32 s73, s72, 151552
s_and_b32 s73, s73, 0x3ffff
s_add_u32 s73, s73, s71
buffer_load_dwordx4 v[212:215], v1, s[28:31], s73 offen nt
s_waitcnt vmcnt(11)
s_add_u32 s73, s72, 155648
s_and_b32 s73, s73, 0x3ffff
s_add_u32 s73, s73, s71
buffer_load_dwordx4 v[216:219], v1, s[28:31], s73 offen nt
s_waitcnt vmcnt(11)
s_add_u32 s73, s72, 159744
s_and_b32 s73, s73, 0x3ffff
s_add_u32 s73, s73, s71
buffer_load_dwordx4 v[220:223], v1, s[28:31], s73 offen nt
s_waitcnt vmcnt(11)
s_add_u32 s73, s72, 163840
s_and_b32 s73, s73, 0x3ffff
s_add_u32 s73, s73, s71
buffer_load_dwordx4 v[224:227], v1, s[28:31], s73 offen nt
s_waitcnt vmcnt(11)
s_add_u32 s73, s72, 167936
s_and_b32 s73, s73, 0x3ffff
s_add_u32 s73, s73, s71
buffer_load_dwordx4 v[228:231], v1, s[28:31], s73 offen nt
s_waitcnt vmcnt(11)
s_add_u32 s73, s72, 172032
s_and_b32 s73, s73, 0x3ffff
s_add_u32 s73, s73, s71
buffer_load_dwordx4 v[232:235], v1, s[28:31], s73 offen nt
s_waitcnt vmcnt(11)
s_add_u32 s73, s72, 176128
s_and_b32 s73, s73, 0x3ffff
s_add_u32 s73, s73, s71
buffer_load_dwordx4 v[236:239], v1, s[28:31], s73 offen nt
s_waitcnt vmcnt(11)
s_add_u32 s73, s72, 180224
s_and_b32 s73, s73, 0x3ffff
s_add_u32 s73, s73, s71
buffer_load_dwordx4 v[240:243], v1, s[28:31], s73 offen nt
s_waitcnt vmcnt(11)
s_add_u32 s73, s72, 184320
s_and_b32 s73, s73, 0x3ffff
s_add_u32 s73, s73, s71
buffer_load_dwordx4 v[244:247], v1, s[28:31], s73 offen nt
s_waitcnt vmcnt(11)
s_add_u32 s73, s72, 188416
s_and_b32 s73, s73, 0x3ffff
s_add_u32 s73, s73, s71
buffer_load_dwordx4 v[248:251], v1, s[28:31], s73 offen nt
s_waitcnt vmcnt(11)
s_add_u32 s73, s72, 192512
s_and_b32 s73, s73, 0x3ffff
s_add_u32 s73, s73, s71
buffer_load_dwordx4 v[252:255], v1, s[28:31], s73 offen nt
s_waitcnt vmcnt(11)
s_add_u32 s73, s72, 196608
s_and_b32 s73, s73, 0x3ffff
s_add_u32 s73, s73, s71
s_add_u32 m0, s90, 0
s_nop 0
buffer_load_dwordx4 v1, s[28:31], s73 offen nt lds
s_waitcnt vmcnt(11)
s_add_u32 s73, s72, 200704
s_and_b32 s73, s73, 0x3ffff
s_add_u32 s73, s73, s71
s_add_u32 m0, s90, 1024
s_nop 0
buffer_load_dwordx4 v1, s[28:31], s73 offen nt lds
s_waitcnt vmcnt(11)
s_add_u32 s73, s72, 204800
s_and_b32 s73, s73, 0x3ffff
s_add_u32 s73, s73, s71
s_add_u32 m0, s90, 2048
s_nop 0
buffer_load_dwordx4 v1, s[28:31], s73 offen nt lds
s_waitcnt vmcnt(11)
s_add_u32 s73, s72, 208896
s_and_b32 s73, s73, 0x3ffff
s_add_u32 s73, s73, s71
s_add_u32 m0, s90, 3072
s_nop 0
buffer_load_dwordx4 v1, s[28:31], s73 offen nt lds
s_waitcnt vmcnt(11)
s_add_u32 s73, s72, 212992
s_and_b32 s73, s73, 0x3ffff
s_add_u32 s73, s73, s71
s_add_u32 m0, s90, 4096
s_nop 0
buffer_load_dwordx4 v1, s[28:31], s73 offen nt lds
s_waitcnt vmcnt(11)
s_add_u32 s73, s72, 217088
s_and_b32 s73, s73, 0x3ffff
s_add_u32 s73, s73, s71
s_add_u32 m0, s90, 5120
s_nop 0
buffer_load_dwordx4 v1, s[28:31], s73 offen nt lds
s_waitcnt vmcnt(11)
s_add_u32 s73, s72, 221184
s_and_b32 s73, s73, 0x3ffff
s_add_u32 s73, s73, s71
s_add_u32 m0, s90, 6144
s_nop 0
buffer_load_dwordx4 v1, s[28:31], s73 offen nt lds
s_waitcnt vmcnt(11)
s_add_u32 s73, s72, 225280
s_and_b32 s73, s73, 0x3ffff
s_add_u32 s73, s73, s71
s_add_u32 m0, s90, 7168
s_nop 0
buffer_load_dwordx4 v1, s[28:31], s73 offen nt lds
s_waitcnt vmcnt(11)
s_add_u32 s73, s72, 229376
s_and_b32 s73, s73, 0x3ffff
s_add_u32 s73, s73, s71
s_add_u32 m0, s90, 8192
s_nop 0
buffer_load_dwordx4 v1, s[28:31], s73 offen nt lds
s_waitcnt vmcnt(11)
s_add_u32 s73, s72, 233472
s_and_b32 s73, s73, 0x3ffff
s_add_u32 s73, s73, s71
s_add_u32 m0, s90, 9216
s_nop 0
buffer_load_dwordx4 v1, s[28:31], s73 offen nt lds
s_waitcnt vmcnt(11)
s_add_u32 s73, s72, 237568
s_and_b32 s73, s73, 0x3ffff
s_add_u32 s73, s73, s71
s_add_u32 m0, s90, 10240
s_nop 0
buffer_load_dwordx4 v1, s[28:31], s73 offen nt lds
s_waitcnt vmcnt(11)
s_add_u32 s73, s72, 241664
s_and_b32 s73, s73, 0x3ffff
s_add_u32 s73, s73, s71
s_add_u32 m0, s90, 11264
s_nop 0
buffer_load_dwordx4 v1, s[28:31], s73 offen nt lds
s_waitcnt vmcnt(11)
s_add_u32 s73, s72, 245760
s_and_b32 s73, s73, 0x3ffff
s_add_u32 s73, s73, s71
s_add_u32 m0, s90, 12288
s_nop 0
buffer_load_dwordx4 v1, s[28:31], s73 offen nt lds
s_waitcnt vmcnt(11)
s_add_u32 s73, s72, 249856
s_and_b32 s73, s73, 0x3ffff
s_add_u32 s73, s73, s71
s_add_u32 m0, s90, 13312
s_nop 0
buffer_load_dwordx4 v1, s[28:31], s73 offen nt lds
s_waitcnt vmcnt(11)
s_add_u32 s73, s72, 253952
s_and_b32 s73, s73, 0x3ffff
s_add_u32 s73, s73, s71
s_add_u32 m0, s90, 14336
s_nop 0
buffer_load_dwordx4 v1, s[28:31], s73 offen nt lds
s_waitcnt vmcnt(11)
s_add_u32 s73, s72, 258048
s_and_b32 s73, s73, 0x3ffff
s_add_u32 s73, s73, s71
s_add_u32 m0, s90, 15360
s_nop 0
buffer_load_dwordx4 v1, s[28:31], s73 offen nt lds
s_waitcnt vmcnt(11)
s_add_u32 s73, s72, 0
s_and_b32 s73, s73, 0x3ffff
s_add_u32 s73, s73, s71
s_add_u32 m0, s90, 16384
s_nop 0
buffer_load_dwordx4 v1, s[32:35], s73 offen nt lds
s_waitcnt vmcnt(11)
s_add_u32 s73, s72, 4096
s_and_b32 s73, s73, 0x3ffff
s_add_u32 s73, s73, s71
s_add_u32 m0, s90, 17408
s_nop 0
buffer_load_dwordx4 v1, s[32:35], s73 offen nt lds
s_waitcnt vmcnt(11)
s_add_u32 s73, s72, 8192
s_and_b32 s73, s73, 0x3ffff
s_add_u32 s73, s73, s71
s_add_u32 m0, s90, 18432
s_nop 0
buffer_load_dwordx4 v1, s[32:35], s73 offen nt lds
s_waitcnt vmcnt(11)
s_add_u32 s73, s72, 12288
s_and_b32 s73, s73, 0x3ffff
s_add_u32 s73, s73, s71
s_add_u32 m0, s90, 19456
s_nop 0
buffer_load_dwordx4 v1, s[32:35], s73 offen nt lds
s_waitcnt vmcnt(11)
s_add_u32 s73, s72, 16384
s_and_b32 s73, s73, 0x3ffff
s_add_u32 s73, s73, s71
s_add_u32 m0, s90, 20480
s_nop 0
buffer_load_dwordx4 v1, s[32:35], s73 offen nt lds
s_waitcnt vmcnt(11)
s_add_u32 s73, s72, 20480
s_and_b32 s73, s73, 0x3ffff
s_add_u32 s73, s73, s71
s_add_u32 m0, s90, 21504
s_nop 0
buffer_load_dwordx4 v1, s[32:35], s73 offen nt lds
s_waitcnt vmcnt(11)
s_add_u32 s73, s72, 24576
s_and_b32 s73, s73, 0x3ffff
s_add_u32 s73, s73, s71
s_add_u32 m0, s90, 22528
s_nop 0
buffer_load_dwordx4 v1, s[32:35], s73 offen nt lds
s_waitcnt vmcnt(11)
s_add_u32 s73, s72, 28672
s_and_b32 s73, s73, 0x3ffff
s_add_u32 s73, s73, s71
s_add_u32 m0, s90, 23552
s_nop 0
buffer_load_dwordx4 v1, s[32:35], s73 offen nt lds
s_waitcnt vmcnt(11)
s_add_u32 s73, s72, 32768
s_and_b32 s73, s73, 0x3ffff
s_add_u32 s73, s73, s71
s_add_u32 m0, s90, 24576
s_nop 0
buffer_load_dwordx4 v1, s[32:35], s73 offen nt lds
s_waitcnt vmcnt(11)
s_add_u32 s73, s72, 36864
s_and_b32 s73, s73, 0x3ffff
s_add_u32 s73, s73, s71
s_add_u32 m0, s90, 25600
s_nop 0
buffer_load_dwordx4 v1, s[32:35], s73 offen nt lds
s_waitcnt vmcnt(11)
s_add_u32 s73, s72, 40960
s_and_b32 s73, s73, 0x3ffff
s_add_u32 s73, s73, s71
s_add_u32 m0, s90, 26624
s_nop 0
buffer_load_dwordx4 v1, s[32:35], s73 offen nt lds
s_waitcnt vmcnt(11)
s_add_u32 s73, s72, 45056
s_and_b32 s73, s73, 0x3ffff
s_add_u32 s73, s73, s71
s_add_u32 m0, s90, 27648
s_nop 0
buffer_load_dwordx4 v1, s[32:35], s73 offen nt lds
s_waitcnt vmcnt(11)
s_add_u32 s73, s72, 49152
s_and_b32 s73, s73, 0x3ffff
s_add_u32 s73, s73, s71
s_add_u32 m0, s90, 28672
s_nop 0
buffer_load_dwordx4 v1, s[32:35], s73 offen nt lds
s_waitcnt vmcnt(11)
s_add_u32 s73, s72, 53248
s_and_b32 s73, s73, 0x3ffff
s_add_u32 s73, s73, s71
s_add_u32 m0, s90, 29696
s_nop 0
buffer_load_dwordx4 v1, s[32:35], s73 offen nt lds
s_waitcnt vmcnt(11)
s_add_u32 s73, s72, 57344
s_and_b32 s73, s73, 0x3ffff
s_add_u32 s73, s73, s71
s_add_u32 m0, s90, 30720
s_nop 0
buffer_load_dwordx4 v1, s[32:35], s73 offen nt lds
s_waitcnt vmcnt(11)
s_add_u32 s73, s72, 61440
s_and_b32 s73, s73, 0x3ffff
s_add_u32 s73, s73, s71
s_add_u32 m0, s90, 31744
s_nop 0
buffer_load_dwordx4 v1, s[32:35], s73 offen nt lds
v_mov_b32 v13, 264
s_mov_b32 s96, 0
L_qspin_1:
ds_read_b32 v12, v13
s_add_u32 s96, s96, 1
s_waitcnt lgkmcnt(0)
v_readfirstlane_b32 s73, v12
s_nop 0
s_cmp_lg_u32 s73, 0
s_cbranch_scc1 L_qok_2
s_sleep 2
s_cmp_lt_u32 s96, 16777216
s_cbranch_scc1 L_qspin_1
L_qok_2:
v_lshlrev_b32 v12, 4, v6
ds_read_b128 v[8:11], v12 offset:0
v_mov_b32 v13, 256
ds_read_b64 v[32:33], v13
ds_read_b32 v34, v13 offset:56
s_waitcnt lgkmcnt(0)
v_readfirstlane_b32 s26, v32
v_readfirstlane_b32 s27, v33
v_readfirstlane_b32 s25, v34
s_waitcnt vmcnt(63)
v_dot2_f32_bf16 v16, v64, v8, 0
v_dot2_f32_bf16 v17, v68, v8, 0
v_dot2_f32_bf16 v18, v72, v8, 0
v_dot2_f32_bf16 v19, v76, v8, 0
v_dot2_f32_bf16 v16, v65, v9, v16
v_dot2_f32_bf16 v17, v69, v9, v17
v_dot2_f32_bf16 v18, v73, v9, v18
v_dot2_f32_bf16 v19, v77, v9, v19
v_dot2_f32_bf16 v16, v66, v10, v16
v_dot2_f32_bf16 v17, v70, v10, v17
v_dot2_f32_bf16 v18, v74, v10, v18
v_dot2_f32_bf16 v19, v78, v10, v19
v_dot2_f32_bf16 v16, v67, v11, v16
v_dot2_f32_bf16 v17, v71, v11, v17
v_dot2_f32_bf16 v18, v75, v11, v18
v_dot2_f32_bf16 v19, v79, v11, v19
s_waitcnt vmcnt(63)
v_dot2_f32_bf16 v20, v80, v8, 0
v_dot2_f32_bf16 v21, v84, v8, 0
v_dot2_f32_bf16 v22, v88, v8, 0
v_dot2_f32_bf16 v23, v92, v8, 0
v_dot2_f32_bf16 v20, v81, v9, v20
v_dot2_f32_bf16 v21, v85, v9, v21
v_dot2_f32_bf16 v22, v89, v9, v22
v_dot2_f32_bf16 v23, v93, v9, v23
v_dot2_f32_bf16 v20, v82, v10, v20
v_dot2_f32_bf16 v21, v86, v10, v21
v_dot2_f32_bf16 v22, v90, v10, v22
v_dot2_f32_bf16 v23, v94, v10, v23
v_dot2_f32_bf16 v20, v83, v11, v20
v_dot2_f32_bf16 v21, v87, v11, v21
v_dot2_f32_bf16 v22, v91, v11, v22
v_dot2_f32_bf16 v23, v95, v11, v23
s_waitcnt vmcnt(63)
v_dot2_f32_bf16 v24, v96, v8, 0
v_dot2_f32_bf16 v25, v100, v8, 0
v_dot2_f32_bf16 v26, v104, v8, 0
v_dot2_f32_bf16 v27, v108, v8, 0
v_dot2_f32_bf16 v24, v97, v9, v24
v_dot2_f32_bf16 v25, v101, v9, v25
v_dot2_f32_bf16 v26, v105, v9, v26
v_dot2_f32_bf16 v27, v109, v9, v27
v_dot2_f32_bf16 v24, v98, v10, v24
v_dot2_f32_bf16 v25, v102, v10, v25
v_dot2_f32_bf16 v26, v106, v10, v26
v_dot2_f32_bf16 v27, v110, v10, v27
v_dot2_f32_bf16 v24, v99, v11, v24
v_dot2_f32_bf16 v25, v103, v11, v25
v_dot2_f32_bf16 v26, v107, v11, v26
v_dot2_f32_bf16 v27, v111, v11, v27
s_waitcnt vmcnt(11)
s_add_u32 s73, s72, 65536
s_and_b32 s73, s73, 0x3ffff
s_add_u32 s73, s73, s71
buffer_load_dwordx4 v[64:67], v1, s[32:35], s73 offen nt
s_waitcnt vmcnt(11)
s_add_u32 s73, s72, 69632
s_and_b32 s73, s73, 0x3ffff
s_add_u32 s73, s73, s71
buffer_load_dwordx4 v[68:71], v1, s[32:35], s73 offen nt
s_waitcnt vmcnt(11)
s_add_u32 s73, s72, 73728
s_and_b32 s73, s73, 0x3ffff
s_add_u32 s73, s73, s71
buffer_load_dwordx4 v[72:75], v1, s[32:35], s73 offen nt
s_waitcnt vmcnt(11)
s_add_u32 s73, s72, 77824
s_and_b32 s73, s73, 0x3ffff
s_add_u32 s73, s73, s71
buffer_load_dwordx4 v[76:79], v1, s[32:35], s73 offen nt
s_waitcnt vmcnt(63)
v_dot2_f32_bf16 v28, v112, v8, 0
v_dot2_f32_bf16 v29, v116, v8, 0
v_dot2_f32_bf16 v30, v120, v8, 0
v_dot2_f32_bf16 v31, v124, v8, 0
v_dot2_f32_bf16 v28, v113, v9, v28
v_dot2_f32_bf16 v29, v117, v9, v29
v_dot2_f32_bf16 v30, v121, v9, v30
v_dot2_f32_bf16 v31, v125, v9, v31
v_dot2_f32_bf16 v28, v114, v10, v28
v_dot2_f32_bf16 v29, v118, v10, v29
v_dot2_f32_bf16 v30, v122, v10, v30
v_dot2_f32_bf16 v31, v126, v10, v31
v_dot2_f32_bf16 v28, v115, v11, v28
v_dot2_f32_bf16 v29, v119, v11, v29
v_dot2_f32_bf16 v30, v123, v11, v30
v_dot2_f32_bf16 v31, v127, v11, v31
v_add_f32_dpp v16, v16, v16 row_ror:8 row_mask:0xf bank_mask:0x3
v_add_f32_dpp v17, v17, v17 row_ror:8 row_mask:0xf bank_mask:0x3
v_add_f32_dpp v18, v18, v18 row_ror:8 row_mask:0xf bank_mask:0x3
v_add_f32_dpp v19, v19, v19 row_ror:8 row_mask:0xf bank_mask:0x3
v_add_f32_dpp v20, v20, v20 row_ror:8 row_mask:0xf bank_mask:0x3
v_add_f32_dpp v21, v21, v21 row_ror:8 row_mask:0xf bank_mask:0x3
v_add_f32_dpp v22, v22, v22 row_ror:8 row_mask:0xf bank_mask:0x3
v_add_f32_dpp v23, v23, v23 row_ror:8 row_mask:0xf bank_mask:0x3
v_add_f32_dpp v16, v24, v24 row_ror:8 row_mask:0xf bank_mask:0xc
v_add_f32_dpp v17, v25, v25 row_ror:8 row_mask:0xf bank_mask:0xc
v_add_f32_dpp v18, v26, v26 row_ror:8 row_mask:0xf bank_mask:0xc
v_add_f32_dpp v19, v27, v27 row_ror:8 row_mask:0xf bank_mask:0xc
v_add_f32_dpp v20, v28, v28 row_ror:8 row_mask:0xf bank_mask:0xc
v_add_f32_dpp v21, v29, v29 row_ror:8 row_mask:0xf bank_mask:0xc
v_add_f32_dpp v22, v30, v30 row_ror:8 row_mask:0xf bank_mask:0xc
v_add_f32_dpp v23, v31, v31 row_ror:8 row_mask:0xf bank_mask:0xc
v_add_f32_dpp v16, v16, v16 row_shl:4 row_mask:0xf bank_mask:0x5
v_add_f32_dpp v17, v17, v17 row_shl:4 row_mask:0xf bank_mask:0x5
v_add_f32_dpp v18, v18, v18 row_shl:4 row_mask:0xf bank_mask:0x5
v_add_f32_dpp v19, v19, v19 row_shl:4 row_mask:0xf bank_mask:0x5
v_add_f32_dpp v16, v20, v20 row_shr:4 row_mask:0xf bank_mask:0xa
v_add_f32_dpp v17, v21, v21 row_shr:4 row_mask:0xf bank_mask:0xa
v_add_f32_dpp v18, v22, v22 row_shr:4 row_mask:0xf bank_mask:0xa
v_add_f32_dpp v19, v23, v23 row_shr:4 row_mask:0xf bank_mask:0xa
v_cndmask_b32 v20, v16, v18, s[78:79]
v_cndmask_b32 v22, v18, v16, s[78:79]
v_cndmask_b32 v21, v17, v19, s[78:79]
v_cndmask_b32 v23, v19, v17, s[78:79]
v_add_f32_dpp v16, v22, v20 quad_perm:[2,3,0,1] row_mask:0xf bank_mask:0xf
s_nop 0
v_add_f32_dpp v17, v23, v21 quad_perm:[2,3,0,1] row_mask:0xf bank_mask:0xf
v_cndmask_b32 v20, v16, v17, s[76:77]
v_cndmask_b32 v22, v17, v16, s[76:77]
s_nop 1
v_add_f32_dpp v32, v22, v20 quad_perm:[1,0,3,2] row_mask:0xf bank_mask:0xf
v_cvt_pk_bf16_f32 v32, v32, v32
v_and_b32 v32, 0xffff0000, v32
v_mul_f32 v32, 0x3db504f3, v32
v_cvt_pk_bf16_f32 v32, v32, v32
v_and_b32 v32, 0xffff0000, v32
s_waitcnt vmcnt(63)
v_dot2_f32_bf16 v16, v128, v8, 0
v_dot2_f32_bf16 v17, v132, v8, 0
v_dot2_f32_bf16 v18, v136, v8, 0
v_dot2_f32_bf16 v19, v140, v8, 0
v_dot2_f32_bf16 v16, v129, v9, v16
v_dot2_f32_bf16 v17, v133, v9, v17
v_dot2_f32_bf16 v18, v137, v9, v18
v_dot2_f32_bf16 v19, v141, v9, v19
v_dot2_f32_bf16 v16, v130, v10, v16
v_dot2_f32_bf16 v17, v134, v10, v17
v_dot2_f32_bf16 v18, v138, v10, v18
v_dot2_f32_bf16 v19, v142, v10, v19
v_dot2_f32_bf16 v16, v131, v11, v16
v_dot2_f32_bf16 v17, v135, v11, v17
v_dot2_f32_bf16 v18, v139, v11, v18
v_dot2_f32_bf16 v19, v143, v11, v19
s_waitcnt vmcnt(60)
v_dot2_f32_bf16 v20, v144, v8, 0
v_dot2_f32_bf16 v21, v148, v8, 0
v_dot2_f32_bf16 v22, v152, v8, 0
v_dot2_f32_bf16 v23, v156, v8, 0
v_dot2_f32_bf16 v20, v145, v9, v20
v_dot2_f32_bf16 v21, v149, v9, v21
v_dot2_f32_bf16 v22, v153, v9, v22
v_dot2_f32_bf16 v23, v157, v9, v23
v_dot2_f32_bf16 v20, v146, v10, v20
v_dot2_f32_bf16 v21, v150, v10, v21
v_dot2_f32_bf16 v22, v154, v10, v22
v_dot2_f32_bf16 v23, v158, v10, v23
v_dot2_f32_bf16 v20, v147, v11, v20
v_dot2_f32_bf16 v21, v151, v11, v21
v_dot2_f32_bf16 v22, v155, v11, v22
v_dot2_f32_bf16 v23, v159, v11, v23
s_waitcnt vmcnt(11)
s_add_u32 s73, s72, 81920
s_and_b32 s73, s73, 0x3ffff
s_add_u32 s73, s73, s71
buffer_load_dwordx4 v[80:83], v1, s[32:35], s73 offen nt
s_waitcnt vmcnt(11)
s_add_u32 s73, s72, 86016
s_and_b32 s73, s73, 0x3ffff
s_add_u32 s73, s73, s71
buffer_load_dwordx4 v[84:87], v1, s[32:35], s73 offen nt
s_waitcnt vmcnt(11)
s_add_u32 s73, s72, 90112
s_and_b32 s73, s73, 0x3ffff
s_add_u32 s73, s73, s71
buffer_load_dwordx4 v[88:91], v1, s[32:35], s73 offen nt
s_waitcnt vmcnt(11)
s_add_u32 s73, s72, 94208
s_and_b32 s73, s73, 0x3ffff
s_add_u32 s73, s73, s71
buffer_load_dwordx4 v[92:95], v1, s[32:35], s73 offen nt
s_waitcnt vmcnt(60)
v_dot2_f32_bf16 v24, v160, v8, 0
v_dot2_f32_bf16 v25, v164, v8, 0
v_dot2_f32_bf16 v26, v168, v8, 0
v_dot2_f32_bf16 v27, v172, v8, 0
v_dot2_f32_bf16 v24, v161, v9, v24
v_dot2_f32_bf16 v25, v165, v9, v25
v_dot2_f32_bf16 v26, v169, v9, v26
v_dot2_f32_bf16 v27, v173, v9, v27
v_dot2_f32_bf16 v24, v162, v10, v24
v_dot2_f32_bf16 v25, v166, v10, v25
v_dot2_f32_bf16 v26, v170, v10, v26
v_dot2_f32_bf16 v27, v174, v10, v27
v_dot2_f32_bf16 v24, v163, v11, v24
v_dot2_f32_bf16 v25, v167, v11, v25
v_dot2_f32_bf16 v26, v171, v11, v26
v_dot2_f32_bf16 v27, v175, v11, v27
s_waitcnt vmcnt(56)
v_dot2_f32_bf16 v28, v176, v8, 0
v_dot2_f32_bf16 v29, v180, v8, 0
v_dot2_f32_bf16 v30, v184, v8, 0
v_dot2_f32_bf16 v31, v188, v8, 0
v_dot2_f32_bf16 v28, v177, v9, v28
v_dot2_f32_bf16 v29, v181, v9, v29
v_dot2_f32_bf16 v30, v185, v9, v30
v_dot2_f32_bf16 v31, v189, v9, v31
v_dot2_f32_bf16 v28, v178, v10, v28
v_dot2_f32_bf16 v29, v182, v10, v29
v_dot2_f32_bf16 v30, v186, v10, v30
v_dot2_f32_bf16 v31, v190, v10, v31
v_dot2_f32_bf16 v28, v179, v11, v28
v_dot2_f32_bf16 v29, v183, v11, v29
v_dot2_f32_bf16 v30, v187, v11, v30
v_dot2_f32_bf16 v31, v191, v11, v31
v_add_f32_dpp v16, v16, v16 row_ror:8 row_mask:0xf bank_mask:0x3
v_add_f32_dpp v17, v17, v17 row_ror:8 row_mask:0xf bank_mask:0x3
v_add_f32_dpp v18, v18, v18 row_ror:8 row_mask:0xf bank_mask:0x3
v_add_f32_dpp v19, v19, v19 row_ror:8 row_mask:0xf bank_mask:0x3
v_add_f32_dpp v20, v20, v20 row_ror:8 row_mask:0xf bank_mask:0x3
v_add_f32_dpp v21, v21, v21 row_ror:8 row_mask:0xf bank_mask:0x3
v_add_f32_dpp v22, v22, v22 row_ror:8 row_mask:0xf bank_mask:0x3
v_add_f32_dpp v23, v23, v23 row_ror:8 row_mask:0xf bank_mask:0x3
v_add_f32_dpp v16, v24, v24 row_ror:8 row_mask:0xf bank_mask:0xc
v_add_f32_dpp v17, v25, v25 row_ror:8 row_mask:0xf bank_mask:0xc
v_add_f32_dpp v18, v26, v26 row_ror:8 row_mask:0xf bank_mask:0xc
v_add_f32_dpp v19, v27, v27 row_ror:8 row_mask:0xf bank_mask:0xc
v_add_f32_dpp v20, v28, v28 row_ror:8 row_mask:0xf bank_mask:0xc
v_add_f32_dpp v21, v29, v29 row_ror:8 row_mask:0xf bank_mask:0xc
v_add_f32_dpp v22, v30, v30 row_ror:8 row_mask:0xf bank_mask:0xc
v_add_f32_dpp v23, v31, v31 row_ror:8 row_mask:0xf bank_mask:0xc
v_add_f32_dpp v16, v16, v16 row_shl:4 row_mask:0xf bank_mask:0x5
v_add_f32_dpp v17, v17, v17 row_shl:4 row_mask:0xf bank_mask:0x5
v_add_f32_dpp v18, v18, v18 row_shl:4 row_mask:0xf bank_mask:0x5
v_add_f32_dpp v19, v19, v19 row_shl:4 row_mask:0xf bank_mask:0x5
v_add_f32_dpp v16, v20, v20 row_shr:4 row_mask:0xf bank_mask:0xa
v_add_f32_dpp v17, v21, v21 row_shr:4 row_mask:0xf bank_mask:0xa
v_add_f32_dpp v18, v22, v22 row_shr:4 row_mask:0xf bank_mask:0xa
v_add_f32_dpp v19, v23, v23 row_shr:4 row_mask:0xf bank_mask:0xa
v_cndmask_b32 v20, v16, v18, s[78:79]
v_cndmask_b32 v22, v18, v16, s[78:79]
v_cndmask_b32 v21, v17, v19, s[78:79]
v_cndmask_b32 v23, v19, v17, s[78:79]
v_add_f32_dpp v16, v22, v20 quad_perm:[2,3,0,1] row_mask:0xf bank_mask:0xf
s_nop 0
v_add_f32_dpp v17, v23, v21 quad_perm:[2,3,0,1] row_mask:0xf bank_mask:0xf
v_cndmask_b32 v20, v16, v17, s[76:77]
v_cndmask_b32 v22, v17, v16, s[76:77]
s_nop 1
v_add_f32_dpp v33, v22, v20 quad_perm:[1,0,3,2] row_mask:0xf bank_mask:0xf
v_cvt_pk_bf16_f32 v33, v33, v33
v_and_b32 v33, 0xffff0000, v33
v_mul_f32 v33, 0x3db504f3, v33
v_cvt_pk_bf16_f32 v33, v33, v33
v_and_b32 v33, 0xffff0000, v33
s_waitcnt vmcnt(52)
v_dot2_f32_bf16 v16, v192, v8, 0
v_dot2_f32_bf16 v17, v196, v8, 0
v_dot2_f32_bf16 v18, v200, v8, 0
v_dot2_f32_bf16 v19, v204, v8, 0
v_dot2_f32_bf16 v16, v193, v9, v16
v_dot2_f32_bf16 v17, v197, v9, v17
v_dot2_f32_bf16 v18, v201, v9, v18
v_dot2_f32_bf16 v19, v205, v9, v19
v_dot2_f32_bf16 v16, v194, v10, v16
v_dot2_f32_bf16 v17, v198, v10, v17
v_dot2_f32_bf16 v18, v202, v10, v18
v_dot2_f32_bf16 v19, v206, v10, v19
v_dot2_f32_bf16 v16, v195, v11, v16
v_dot2_f32_bf16 v17, v199, v11, v17
v_dot2_f32_bf16 v18, v203, v11, v18
v_dot2_f32_bf16 v19, v207, v11, v19
s_waitcnt vmcnt(11)
s_add_u32 s73, s72, 98304
s_and_b32 s73, s73, 0x3ffff
s_add_u32 s73, s73, s71
buffer_load_dwordx4 v[96:99], v1, s[32:35], s73 offen nt
s_waitcnt vmcnt(11)
s_add_u32 s73, s72, 102400
s_and_b32 s73, s73, 0x3ffff
s_add_u32 s73, s73, s71
buffer_load_dwordx4 v[100:103], v1, s[32:35], s73 offen nt
s_waitcnt vmcnt(11)
s_add_u32 s73, s72, 106496
s_and_b32 s73, s73, 0x3ffff
s_add_u32 s73, s73, s71
buffer_load_dwordx4 v[104:107], v1, s[32:35], s73 offen nt
s_waitcnt vmcnt(11)
s_add_u32 s73, s72, 110592
s_and_b32 s73, s73, 0x3ffff
s_add_u32 s73, s73, s71
buffer_load_dwordx4 v[108:111], v1, s[32:35], s73 offen nt
s_waitcnt vmcnt(52)
v_dot2_f32_bf16 v20, v208, v8, 0
v_dot2_f32_bf16 v21, v212, v8, 0
v_dot2_f32_bf16 v22, v216, v8, 0
v_dot2_f32_bf16 v23, v220, v8, 0
v_dot2_f32_bf16 v20, v209, v9, v20
v_dot2_f32_bf16 v21, v213, v9, v21
v_dot2_f32_bf16 v22, v217, v9, v22
v_dot2_f32_bf16 v23, v221, v9, v23
v_dot2_f32_bf16 v20, v210, v10, v20
v_dot2_f32_bf16 v21, v214, v10, v21
v_dot2_f32_bf16 v22, v218, v10, v22
v_dot2_f32_bf16 v23, v222, v10, v23
v_dot2_f32_bf16 v20, v211, v11, v20
v_dot2_f32_bf16 v21, v215, v11, v21
v_dot2_f32_bf16 v22, v219, v11, v22
v_dot2_f32_bf16 v23, v223, v11, v23
s_waitcnt vmcnt(48)
v_dot2_f32_bf16 v24, v224, v8, 0
v_dot2_f32_bf16 v25, v228, v8, 0
v_dot2_f32_bf16 v26, v232, v8, 0
v_dot2_f32_bf16 v27, v236, v8, 0
v_dot2_f32_bf16 v24, v225, v9, v24
v_dot2_f32_bf16 v25, v229, v9, v25
v_dot2_f32_bf16 v26, v233, v9, v26
v_dot2_f32_bf16 v27, v237, v9, v27
v_dot2_f32_bf16 v24, v226, v10, v24
v_dot2_f32_bf16 v25, v230, v10, v25
v_dot2_f32_bf16 v26, v234, v10, v26
v_dot2_f32_bf16 v27, v238, v10, v27
v_dot2_f32_bf16 v24, v227, v11, v24
v_dot2_f32_bf16 v25, v231, v11, v25
v_dot2_f32_bf16 v26, v235, v11, v26
v_dot2_f32_bf16 v27, v239, v11, v27
s_waitcnt vmcnt(44)
v_dot2_f32_bf16 v28, v240, v8, 0
v_dot2_f32_bf16 v29, v244, v8, 0
v_dot2_f32_bf16 v30, v248, v8, 0
v_dot2_f32_bf16 v31, v252, v8, 0
v_dot2_f32_bf16 v28, v241, v9, v28
v_dot2_f32_bf16 v29, v245, v9, v29
v_dot2_f32_bf16 v30, v249, v9, v30
v_dot2_f32_bf16 v31, v253, v9, v31
v_dot2_f32_bf16 v28, v242, v10, v28
v_dot2_f32_bf16 v29, v246, v10, v29
v_dot2_f32_bf16 v30, v250, v10, v30
v_dot2_f32_bf16 v31, v254, v10, v31
v_dot2_f32_bf16 v28, v243, v11, v28
v_dot2_f32_bf16 v29, v247, v11, v29
v_dot2_f32_bf16 v30, v251, v11, v30
v_dot2_f32_bf16 v31, v255, v11, v31
v_add_f32_dpp v16, v16, v16 row_ror:8 row_mask:0xf bank_mask:0x3
v_add_f32_dpp v17, v17, v17 row_ror:8 row_mask:0xf bank_mask:0x3
v_add_f32_dpp v18, v18, v18 row_ror:8 row_mask:0xf bank_mask:0x3
v_add_f32_dpp v19, v19, v19 row_ror:8 row_mask:0xf bank_mask:0x3
v_add_f32_dpp v20, v20, v20 row_ror:8 row_mask:0xf bank_mask:0x3
v_add_f32_dpp v21, v21, v21 row_ror:8 row_mask:0xf bank_mask:0x3
v_add_f32_dpp v22, v22, v22 row_ror:8 row_mask:0xf bank_mask:0x3
v_add_f32_dpp v23, v23, v23 row_ror:8 row_mask:0xf bank_mask:0x3
v_add_f32_dpp v16, v24, v24 row_ror:8 row_mask:0xf bank_mask:0xc
v_add_f32_dpp v17, v25, v25 row_ror:8 row_mask:0xf bank_mask:0xc
v_add_f32_dpp v18, v26, v26 row_ror:8 row_mask:0xf bank_mask:0xc
v_add_f32_dpp v19, v27, v27 row_ror:8 row_mask:0xf bank_mask:0xc
v_add_f32_dpp v20, v28, v28 row_ror:8 row_mask:0xf bank_mask:0xc
v_add_f32_dpp v21, v29, v29 row_ror:8 row_mask:0xf bank_mask:0xc
v_add_f32_dpp v22, v30, v30 row_ror:8 row_mask:0xf bank_mask:0xc
v_add_f32_dpp v23, v31, v31 row_ror:8 row_mask:0xf bank_mask:0xc
v_add_f32_dpp v16, v16, v16 row_shl:4 row_mask:0xf bank_mask:0x5
v_add_f32_dpp v17, v17, v17 row_shl:4 row_mask:0xf bank_mask:0x5
v_add_f32_dpp v18, v18, v18 row_shl:4 row_mask:0xf bank_mask:0x5
v_add_f32_dpp v19, v19, v19 row_shl:4 row_mask:0xf bank_mask:0x5
v_add_f32_dpp v16, v20, v20 row_shr:4 row_mask:0xf bank_mask:0xa
v_add_f32_dpp v17, v21, v21 row_shr:4 row_mask:0xf bank_mask:0xa
v_add_f32_dpp v18, v22, v22 row_shr:4 row_mask:0xf bank_mask:0xa
v_add_f32_dpp v19, v23, v23 row_shr:4 row_mask:0xf bank_mask:0xa
v_cndmask_b32 v20, v16, v18, s[78:79]
v_cndmask_b32 v22, v18, v16, s[78:79]
v_cndmask_b32 v21, v17, v19, s[78:79]
v_cndmask_b32 v23, v19, v17, s[78:79]
v_add_f32_dpp v16, v22, v20 quad_perm:[2,3,0,1] row_mask:0xf bank_mask:0xf
s_nop 0
v_add_f32_dpp v17, v23, v21 quad_perm:[2,3,0,1] row_mask:0xf bank_mask:0xf
v_cndmask_b32 v20, v16, v17, s[76:77]
v_cndmask_b32 v22, v17, v16, s[76:77]
s_nop 1
v_add_f32_dpp v34, v22, v20 quad_perm:[1,0,3,2] row_mask:0xf bank_mask:0xf
v_cvt_pk_bf16_f32 v34, v34, v34
v_and_b32 v34, 0xffff0000, v34
v_mul_f32 v34, 0x3db504f3, v34
v_cvt_pk_bf16_f32 v34, v34, v34
v_and_b32 v34, 0xffff0000, v34
s_waitcnt vmcnt(11)
s_add_u32 s73, s72, 114688
s_and_b32 s73, s73, 0x3ffff
s_add_u32 s73, s73, s71
buffer_load_dwordx4 v[112:115], v1, s[32:35], s73 offen nt
s_waitcnt vmcnt(11)
s_add_u32 s73, s72, 118784
s_and_b32 s73, s73, 0x3ffff
s_add_u32 s73, s73, s71
buffer_load_dwordx4 v[116:119], v1, s[32:35], s73 offen nt
s_waitcnt vmcnt(11)
s_add_u32 s73, s72, 122880
s_and_b32 s73, s73, 0x3ffff
s_add_u32 s73, s73, s71
buffer_load_dwordx4 v[120:123], v1, s[32:35], s73 offen nt
s_waitcnt vmcnt(11)
s_add_u32 s73, s72, 126976
s_and_b32 s73, s73, 0x3ffff
s_add_u32 s73, s73, s71
buffer_load_dwordx4 v[124:127], v1, s[32:35], s73 offen nt
s_waitcnt vmcnt(44)
ds_read_b128 v[36:39], v52 offset:0
ds_read_b128 v[40:43], v52 offset:1024
ds_read_b128 v[44:47], v52 offset:2048
ds_read_b128 v[48:51], v52 offset:3072
s_waitcnt lgkmcnt(0)
v_dot2_f32_bf16 v16, v36, v8, 0
v_dot2_f32_bf16 v17, v40, v8, 0
v_dot2_f32_bf16 v18, v44, v8, 0
v_dot2_f32_bf16 v19, v48, v8, 0
v_dot2_f32_bf16 v16, v37, v9, v16
v_dot2_f32_bf16 v17, v41, v9, v17
v_dot2_f32_bf16 v18, v45, v9, v18
v_dot2_f32_bf16 v19, v49, v9, v19
v_dot2_f32_bf16 v16, v38, v10, v16
v_dot2_f32_bf16 v17, v42, v10, v17
v_dot2_f32_bf16 v18, v46, v10, v18
v_dot2_f32_bf16 v19, v50, v10, v19
v_dot2_f32_bf16 v16, v39, v11, v16
v_dot2_f32_bf16 v17, v43, v11, v17
v_dot2_f32_bf16 v18, v47, v11, v18
v_dot2_f32_bf16 v19, v51, v11, v19
s_waitcnt vmcnt(40)
ds_read_b128 v[36:39], v52 offset:4096
ds_read_b128 v[40:43], v52 offset:5120
ds_read_b128 v[44:47], v52 offset:6144
ds_read_b128 v[48:51], v52 offset:7168
s_waitcnt vmcnt(11)
s_add_u32 s73, s72, 131072
s_and_b32 s73, s73, 0x3ffff
s_add_u32 s73, s73, s71
buffer_load_dwordx4 v[128:131], v1, s[32:35], s73 offen nt
s_waitcnt vmcnt(11)
s_add_u32 s73, s72, 135168
s_and_b32 s73, s73, 0x3ffff
s_add_u32 s73, s73, s71
buffer_load_dwordx4 v[132:135], v1, s[32:35], s73 offen nt
s_waitcnt vmcnt(11)
s_add_u32 s73, s72, 139264
s_and_b32 s73, s73, 0x3ffff
s_add_u32 s73, s73, s71
buffer_load_dwordx4 v[136:139], v1, s[32:35], s73 offen nt
s_waitcnt vmcnt(11)
s_add_u32 s73, s72, 143360
s_and_b32 s73, s73, 0x3ffff
s_add_u32 s73, s73, s71
buffer_load_dwordx4 v[140:143], v1, s[32:35], s73 offen nt
s_waitcnt lgkmcnt(0)
v_dot2_f32_bf16 v20, v36, v8, 0
v_dot2_f32_bf16 v21, v40, v8, 0
v_dot2_f32_bf16 v22, v44, v8, 0
v_dot2_f32_bf16 v23, v48, v8, 0
v_dot2_f32_bf16 v20, v37, v9, v20
v_dot2_f32_bf16 v21, v41, v9, v21
v_dot2_f32_bf16 v22, v45, v9, v22
v_dot2_f32_bf16 v23, v49, v9, v23
v_dot2_f32_bf16 v20, v38, v10, v20
v_dot2_f32_bf16 v21, v42, v10, v21
v_dot2_f32_bf16 v22, v46, v10, v22
v_dot2_f32_bf16 v23, v50, v10, v23
v_dot2_f32_bf16 v20, v39, v11, v20
v_dot2_f32_bf16 v21, v43, v11, v21
v_dot2_f32_bf16 v22, v47, v11, v22
v_dot2_f32_bf16 v23, v51, v11, v23
s_waitcnt vmcnt(40)
ds_read_b128 v[36:39], v52 offset:8192
ds_read_b128 v[40:43], v52 offset:9216
ds_read_b128 v[44:47], v52 offset:10240
ds_read_b128 v[48:51], v52 offset:11264
s_waitcnt lgkmcnt(0)
v_dot2_f32_bf16 v24, v36, v8, 0
v_dot2_f32_bf16 v25, v40, v8, 0
v_dot2_f32_bf16 v26, v44, v8, 0
v_dot2_f32_bf16 v27, v48, v8, 0
v_dot2_f32_bf16 v24, v37, v9, v24
v_dot2_f32_bf16 v25, v41, v9, v25
v_dot2_f32_bf16 v26, v45, v9, v26
v_dot2_f32_bf16 v27, v49, v9, v27
v_dot2_f32_bf16 v24, v38, v10, v24
v_dot2_f32_bf16 v25, v42, v10, v25
v_dot2_f32_bf16 v26, v46, v10, v26
v_dot2_f32_bf16 v27, v50, v10, v27
v_dot2_f32_bf16 v24, v39, v11, v24
v_dot2_f32_bf16 v25, v43, v11, v25
v_dot2_f32_bf16 v26, v47, v11, v26
v_dot2_f32_bf16 v27, v51, v11, v27
s_waitcnt vmcnt(36)
ds_read_b128 v[36:39], v52 offset:12288
ds_read_b128 v[40:43], v52 offset:13312
ds_read_b128 v[44:47], v52 offset:14336
ds_read_b128 v[48:51], v52 offset:15360
s_waitcnt vmcnt(11)
s_add_u32 s73, s72, 147456
s_and_b32 s73, s73, 0x3ffff
s_add_u32 s73, s73, s71
buffer_load_dwordx4 v[144:147], v1, s[32:35], s73 offen nt
s_waitcnt vmcnt(11)
s_add_u32 s73, s72, 151552
s_and_b32 s73, s73, 0x3ffff
s_add_u32 s73, s73, s71
buffer_load_dwordx4 v[148:151], v1, s[32:35], s73 offen nt
s_waitcnt vmcnt(11)
s_add_u32 s73, s72, 155648
s_and_b32 s73, s73, 0x3ffff
s_add_u32 s73, s73, s71
buffer_load_dwordx4 v[152:155], v1, s[32:35], s73 offen nt
s_waitcnt vmcnt(11)
s_add_u32 s73, s72, 159744
s_and_b32 s73, s73, 0x3ffff
s_add_u32 s73, s73, s71
buffer_load_dwordx4 v[156:159], v1, s[32:35], s73 offen nt
s_waitcnt lgkmcnt(0)
v_dot2_f32_bf16 v28, v36, v8, 0
v_dot2_f32_bf16 v29, v40, v8, 0
v_dot2_f32_bf16 v30, v44, v8, 0
v_dot2_f32_bf16 v31, v48, v8, 0
v_dot2_f32_bf16 v28, v37, v9, v28
v_dot2_f32_bf16 v29, v41, v9, v29
v_dot2_f32_bf16 v30, v45, v9, v30
v_dot2_f32_bf16 v31, v49, v9, v31
v_dot2_f32_bf16 v28, v38, v10, v28
v_dot2_f32_bf16 v29, v42, v10, v29
v_dot2_f32_bf16 v30, v46, v10, v30
v_dot2_f32_bf16 v31, v50, v10, v31
v_dot2_f32_bf16 v28, v39, v11, v28
v_dot2_f32_bf16 v29, v43, v11, v29
v_dot2_f32_bf16 v30, v47, v11, v30
v_dot2_f32_bf16 v31, v51, v11, v31
v_add_f32_dpp v16, v16, v16 row_ror:8 row_mask:0xf bank_mask:0x3
v_add_f32_dpp v17, v17, v17 row_ror:8 row_mask:0xf bank_mask:0x3
v_add_f32_dpp v18, v18, v18 row_ror:8 row_mask:0xf bank_mask:0x3
v_add_f32_dpp v19, v19, v19 row_ror:8 row_mask:0xf bank_mask:0x3
v_add_f32_dpp v20, v20, v20 row_ror:8 row_mask:0xf bank_mask:0x3
v_add_f32_dpp v21, v21, v21 row_ror:8 row_mask:0xf bank_mask:0x3
v_add_f32_dpp v22, v22, v22 row_ror:8 row_mask:0xf bank_mask:0x3
v_add_f32_dpp v23, v23, v23 row_ror:8 row_mask:0xf bank_mask:0x3
v_add_f32_dpp v16, v24, v24 row_ror:8 row_mask:0xf bank_mask:0xc
v_add_f32_dpp v17, v25, v25 row_ror:8 row_mask:0xf bank_mask:0xc
v_add_f32_dpp v18, v26, v26 row_ror:8 row_mask:0xf bank_mask:0xc
v_add_f32_dpp v19, v27, v27 row_ror:8 row_mask:0xf bank_mask:0xc
v_add_f32_dpp v20, v28, v28 row_ror:8 row_mask:0xf bank_mask:0xc
v_add_f32_dpp v21, v29, v29 row_ror:8 row_mask:0xf bank_mask:0xc
v_add_f32_dpp v22, v30, v30 row_ror:8 row_mask:0xf bank_mask:0xc
v_add_f32_dpp v23, v31, v31 row_ror:8 row_mask:0xf bank_mask:0xc
v_add_f32_dpp v16, v16, v16 row_shl:4 row_mask:0xf bank_mask:0x5
v_add_f32_dpp v17, v17, v17 row_shl:4 row_mask:0xf bank_mask:0x5
v_add_f32_dpp v18, v18, v18 row_shl:4 row_mask:0xf bank_mask:0x5
v_add_f32_dpp v19, v19, v19 row_shl:4 row_mask:0xf bank_mask:0x5
v_add_f32_dpp v16, v20, v20 row_shr:4 row_mask:0xf bank_mask:0xa
v_add_f32_dpp v17, v21, v21 row_shr:4 row_mask:0xf bank_mask:0xa
v_add_f32_dpp v18, v22, v22 row_shr:4 row_mask:0xf bank_mask:0xa
v_add_f32_dpp v19, v23, v23 row_shr:4 row_mask:0xf bank_mask:0xa
v_cndmask_b32 v20, v16, v18, s[78:79]
v_cndmask_b32 v22, v18, v16, s[78:79]
v_cndmask_b32 v21, v17, v19, s[78:79]
v_cndmask_b32 v23, v19, v17, s[78:79]
v_add_f32_dpp v16, v22, v20 quad_perm:[2,3,0,1] row_mask:0xf bank_mask:0xf
s_nop 0
v_add_f32_dpp v17, v23, v21 quad_perm:[2,3,0,1] row_mask:0xf bank_mask:0xf
v_cndmask_b32 v20, v16, v17, s[76:77]
v_cndmask_b32 v22, v17, v16, s[76:77]
s_nop 1
v_add_f32_dpp v35, v22, v20 quad_perm:[1,0,3,2] row_mask:0xf bank_mask:0xf
v_cvt_pk_bf16_f32 v35, v35, v35
v_and_b32 v35, 0xffff0000, v35
v_mul_f32 v35, 0x3db504f3, v35
v_cvt_pk_bf16_f32 v35, v35, v35
v_and_b32 v35, 0xffff0000, v35
v_max_f32 v16, v32, v33
v_max3_f32 v16, v16, v34, v35
s_nop 1
v_max_f32_dpp v16, v16, v16 row_ror:8 row_mask:0xf bank_mask:0xf
s_nop 1
v_max_f32_dpp v16, v16, v16 row_ror:4 row_mask:0xf bank_mask:0xf
s_nop 1
v_max_f32_dpp v16, v16, v16 row_ror:2 row_mask:0xf bank_mask:0xf
s_nop 1
v_max_f32_dpp v16, v16, v16 row_ror:1 row_mask:0xf bank_mask:0xf
v_mov_b32 v20, v16
s_nop 1
v_permlane16_swap_b32 v16, v20
v_max_f32 v16, v16, v20
v_mov_b32 v20, v16
s_nop 1
v_permlane32_swap_b32 v16, v20
v_max_f32 v16, v16, v20
v_mov_b32 v44, 0
v_mov_b32 v45, 0
v_mov_b32 v46, 0
v_mov_b32 v47, 0
v_mov_b32 v48, 0
v_mov_b32 v49, 0
v_mov_b32 v50, 0
v_mov_b32 v51, 0
v_sub_f32 v32, v32, v16
v_sub_f32 v33, v33, v16
v_sub_f32 v34, v34, v16
v_sub_f32 v35, v35, v16
v_mul_f32 v32, 0x3fb8aa3b, v32
v_mul_f32 v33, 0x3fb8aa3b, v33
v_mul_f32 v34, 0x3fb8aa3b, v34
v_mul_f32 v35, 0x3fb8aa3b, v35
v_exp_f32 v32, v32
v_exp_f32 v33, v33
v_exp_f32 v34, v34
v_exp_f32 v35, v35
v_add_f32 v17, v32, v33
v_add_f32 v20, v34, v35
v_add_f32 v17, v17, v20
v_cvt_pk_bf16_f32 v36, v32, 0
v_cvt_pk_bf16_f32 v40, 0, v32
v_cvt_pk_bf16_f32 v37, v33, 0
v_cvt_pk_bf16_f32 v41, 0, v33
v_cvt_pk_bf16_f32 v38, v34, 0
v_cvt_pk_bf16_f32 v42, 0, v34
v_cvt_pk_bf16_f32 v39, v35, 0
v_cvt_pk_bf16_f32 v43, 0, v35
v_add_f32_dpp v17, v17, v17 row_ror:8 row_mask:0xf bank_mask:0xf
s_nop 1
v_add_f32_dpp v17, v17, v17 row_ror:4 row_mask:0xf bank_mask:0xf
s_nop 1
v_add_f32_dpp v17, v17, v17 row_ror:2 row_mask:0xf bank_mask:0xf
s_nop 1
v_add_f32_dpp v17, v17, v17 row_ror:1 row_mask:0xf bank_mask:0xf
v_mov_b32 v20, v17
s_nop 1
v_permlane16_swap_b32 v17, v20
v_add_f32 v17, v17, v20
v_mov_b32 v20, v17
s_nop 1
v_permlane32_swap_b32 v17, v20
v_add_f32 v17, v17, v20
s_lshl_b32 s73, s3, 3
s_add_u32 s73, s73, 272
v_mov_b32 v20, s73
ds_write_b64 v20, v[16:17]
v_and_b32 v12, 1, v7
v_lshlrev_b32 v12, 1, v12
v_lshrrev_b32 v13, 1, v7
v_or_b32 v12, v12, v13
v_lshl_add_u32 v12, v6, 3, v12
v_lshlrev_b32 v12, 2, v12
s_lshl_b32 s73, s3, 9
s_add_u32 s73, s73, 4096
v_add_u32 v12, s73, v12
s_waitcnt vmcnt(36)
ds_read_b128 v[16:19], v52 offset:16384
ds_read_b128 v[20:23], v52 offset:17408
ds_read_b128 v[24:27], v52 offset:18432
ds_read_b128 v[28:31], v52 offset:19456
s_waitcnt lgkmcnt(0)
v_dot2c_f32_bf16_dpp v44, v36, v16 row_newbcast:0 row_mask:0xf bank_mask:0xf
v_dot2c_f32_bf16_dpp v45, v40, v16 row_newbcast:0 row_mask:0xf bank_mask:0xf
v_dot2c_f32_bf16_dpp v46, v36, v17 row_newbcast:0 row_mask:0xf bank_mask:0xf
v_dot2c_f32_bf16_dpp v47, v40, v17 row_newbcast:0 row_mask:0xf bank_mask:0xf
v_dot2c_f32_bf16_dpp v48, v36, v18 row_newbcast:0 row_mask:0xf bank_mask:0xf
v_dot2c_f32_bf16_dpp v49, v40, v18 row_newbcast:0 row_mask:0xf bank_mask:0xf
v_dot2c_f32_bf16_dpp v50, v36, v19 row_newbcast:0 row_mask:0xf bank_mask:0xf
v_dot2c_f32_bf16_dpp v51, v40, v19 row_newbcast:0 row_mask:0xf bank_mask:0xf
v_dot2c_f32_bf16_dpp v44, v36, v20 row_newbcast:1 row_mask:0xf bank_mask:0xf
v_dot2c_f32_bf16_dpp v45, v40, v20 row_newbcast:1 row_mask:0xf bank_mask:0xf
v_dot2c_f32_bf16_dpp v46, v36, v21 row_newbcast:1 row_mask:0xf bank_mask:0xf
v_dot2c_f32_bf16_dpp v47, v40, v21 row_newbcast:1 row_mask:0xf bank_mask:0xf
v_dot2c_f32_bf16_dpp v48, v36, v22 row_newbcast:1 row_mask:0xf bank_mask:0xf
v_dot2c_f32_bf16_dpp v49, v40, v22 row_newbcast:1 row_mask:0xf bank_mask:0xf
v_dot2c_f32_bf16_dpp v50, v36, v23 row_newbcast:1 row_mask:0xf bank_mask:0xf
v_dot2c_f32_bf16_dpp v51, v40, v23 row_newbcast:1 row_mask:0xf bank_mask:0xf
v_dot2c_f32_bf16_dpp v44, v36, v24 row_newbcast:2 row_mask:0xf bank_mask:0xf
v_dot2c_f32_bf16_dpp v45, v40, v24 row_newbcast:2 row_mask:0xf bank_mask:0xf
v_dot2c_f32_bf16_dpp v46, v36, v25 row_newbcast:2 row_mask:0xf bank_mask:0xf
v_dot2c_f32_bf16_dpp v47, v40, v25 row_newbcast:2 row_mask:0xf bank_mask:0xf
v_dot2c_f32_bf16_dpp v48, v36, v26 row_newbcast:2 row_mask:0xf bank_mask:0xf
v_dot2c_f32_bf16_dpp v49, v40, v26 row_newbcast:2 row_mask:0xf bank_mask:0xf
v_dot2c_f32_bf16_dpp v50, v36, v27 row_newbcast:2 row_mask:0xf bank_mask:0xf
v_dot2c_f32_bf16_dpp v51, v40, v27 row_newbcast:2 row_mask:0xf bank_mask:0xf
v_dot2c_f32_bf16_dpp v44, v36, v28 row_newbcast:3 row_mask:0xf bank_mask:0xf
v_dot2c_f32_bf16_dpp v45, v40, v28 row_newbcast:3 row_mask:0xf bank_mask:0xf
v_dot2c_f32_bf16_dpp v46, v36, v29 row_newbcast:3 row_mask:0xf bank_mask:0xf
v_dot2c_f32_bf16_dpp v47, v40, v29 row_newbcast:3 row_mask:0xf bank_mask:0xf
v_dot2c_f32_bf16_dpp v48, v36, v30 row_newbcast:3 row_mask:0xf bank_mask:0xf
v_dot2c_f32_bf16_dpp v49, v40, v30 row_newbcast:3 row_mask:0xf bank_mask:0xf
v_dot2c_f32_bf16_dpp v50, v36, v31 row_newbcast:3 row_mask:0xf bank_mask:0xf
v_dot2c_f32_bf16_dpp v51, v40, v31 row_newbcast:3 row_mask:0xf bank_mask:0xf
s_cmp_lg_u32 s3, 0
s_cbranch_scc1 L_wos_3
v_mov_b32 v13, 308
v_mov_b32 v14, 1
ds_write_b32 v13, v14
L_wos_3:
s_waitcnt vmcnt(32)
ds_read_b128 v[16:19], v52 offset:20480
ds_read_b128 v[20:23], v52 offset:21504
ds_read_b128 v[24:27], v52 offset:22528
ds_read_b128 v[28:31], v52 offset:23552
s_waitcnt vmcnt(11)
s_add_u32 s73, s72, 163840
s_and_b32 s73, s73, 0x3ffff
s_add_u32 s73, s73, s71
buffer_load_dwordx4 v[160:163], v1, s[32:35], s73 offen nt
s_waitcnt vmcnt(11)
s_add_u32 s73, s72, 167936
s_and_b32 s73, s73, 0x3ffff
s_add_u32 s73, s73, s71
buffer_load_dwordx4 v[164:167], v1, s[32:35], s73 offen nt
s_waitcnt vmcnt(11)
s_add_u32 s73, s72, 172032
s_and_b32 s73, s73, 0x3ffff
s_add_u32 s73, s73, s71
buffer_load_dwordx4 v[168:171], v1, s[32:35], s73 offen nt
s_waitcnt vmcnt(11)
s_add_u32 s73, s72, 176128
s_and_b32 s73, s73, 0x3ffff
s_add_u32 s73, s73, s71
buffer_load_dwordx4 v[172:175], v1, s[32:35], s73 offen nt
s_waitcnt lgkmcnt(0)
v_dot2c_f32_bf16_dpp v44, v36, v16 row_newbcast:4 row_mask:0xf bank_mask:0xf
v_dot2c_f32_bf16_dpp v45, v40, v16 row_newbcast:4 row_mask:0xf bank_mask:0xf
v_dot2c_f32_bf16_dpp v46, v36, v17 row_newbcast:4 row_mask:0xf bank_mask:0xf
v_dot2c_f32_bf16_dpp v47, v40, v17 row_newbcast:4 row_mask:0xf bank_mask:0xf
v_dot2c_f32_bf16_dpp v48, v36, v18 row_newbcast:4 row_mask:0xf bank_mask:0xf
v_dot2c_f32_bf16_dpp v49, v40, v18 row_newbcast:4 row_mask:0xf bank_mask:0xf
v_dot2c_f32_bf16_dpp v50, v36, v19 row_newbcast:4 row_mask:0xf bank_mask:0xf
v_dot2c_f32_bf16_dpp v51, v40, v19 row_newbcast:4 row_mask:0xf bank_mask:0xf
v_dot2c_f32_bf16_dpp v44, v36, v20 row_newbcast:5 row_mask:0xf bank_mask:0xf
v_dot2c_f32_bf16_dpp v45, v40, v20 row_newbcast:5 row_mask:0xf bank_mask:0xf
v_dot2c_f32_bf16_dpp v46, v36, v21 row_newbcast:5 row_mask:0xf bank_mask:0xf
v_dot2c_f32_bf16_dpp v47, v40, v21 row_newbcast:5 row_mask:0xf bank_mask:0xf
v_dot2c_f32_bf16_dpp v48, v36, v22 row_newbcast:5 row_mask:0xf bank_mask:0xf
v_dot2c_f32_bf16_dpp v49, v40, v22 row_newbcast:5 row_mask:0xf bank_mask:0xf
v_dot2c_f32_bf16_dpp v50, v36, v23 row_newbcast:5 row_mask:0xf bank_mask:0xf
v_dot2c_f32_bf16_dpp v51, v40, v23 row_newbcast:5 row_mask:0xf bank_mask:0xf
v_dot2c_f32_bf16_dpp v44, v36, v24 row_newbcast:6 row_mask:0xf bank_mask:0xf
v_dot2c_f32_bf16_dpp v45, v40, v24 row_newbcast:6 row_mask:0xf bank_mask:0xf
v_dot2c_f32_bf16_dpp v46, v36, v25 row_newbcast:6 row_mask:0xf bank_mask:0xf
v_dot2c_f32_bf16_dpp v47, v40, v25 row_newbcast:6 row_mask:0xf bank_mask:0xf
v_dot2c_f32_bf16_dpp v48, v36, v26 row_newbcast:6 row_mask:0xf bank_mask:0xf
v_dot2c_f32_bf16_dpp v49, v40, v26 row_newbcast:6 row_mask:0xf bank_mask:0xf
v_dot2c_f32_bf16_dpp v50, v36, v27 row_newbcast:6 row_mask:0xf bank_mask:0xf
v_dot2c_f32_bf16_dpp v51, v40, v27 row_newbcast:6 row_mask:0xf bank_mask:0xf
v_dot2c_f32_bf16_dpp v44, v36, v28 row_newbcast:7 row_mask:0xf bank_mask:0xf
v_dot2c_f32_bf16_dpp v45, v40, v28 row_newbcast:7 row_mask:0xf bank_mask:0xf
v_dot2c_f32_bf16_dpp v46, v36, v29 row_newbcast:7 row_mask:0xf bank_mask:0xf
v_dot2c_f32_bf16_dpp v47, v40, v29 row_newbcast:7 row_mask:0xf bank_mask:0xf
v_dot2c_f32_bf16_dpp v48, v36, v30 row_newbcast:7 row_mask:0xf bank_mask:0xf
v_dot2c_f32_bf16_dpp v49, v40, v30 row_newbcast:7 row_mask:0xf bank_mask:0xf
v_dot2c_f32_bf16_dpp v50, v36, v31 row_newbcast:7 row_mask:0xf bank_mask:0xf
v_dot2c_f32_bf16_dpp v51, v40, v31 row_newbcast:7 row_mask:0xf bank_mask:0xf
s_waitcnt vmcnt(32)
ds_read_b128 v[16:19], v52 offset:24576
ds_read_b128 v[20:23], v52 offset:25600
ds_read_b128 v[24:27], v52 offset:26624
ds_read_b128 v[28:31], v52 offset:27648
s_waitcnt lgkmcnt(0)
v_dot2c_f32_bf16_dpp v44, v36, v16 row_newbcast:8 row_mask:0xf bank_mask:0xf
v_dot2c_f32_bf16_dpp v45, v40, v16 row_newbcast:8 row_mask:0xf bank_mask:0xf
v_dot2c_f32_bf16_dpp v46, v36, v17 row_newbcast:8 row_mask:0xf bank_mask:0xf
v_dot2c_f32_bf16_dpp v47, v40, v17 row_newbcast:8 row_mask:0xf bank_mask:0xf
v_dot2c_f32_bf16_dpp v48, v36, v18 row_newbcast:8 row_mask:0xf bank_mask:0xf
v_dot2c_f32_bf16_dpp v49, v40, v18 row_newbcast:8 row_mask:0xf bank_mask:0xf
v_dot2c_f32_bf16_dpp v50, v36, v19 row_newbcast:8 row_mask:0xf bank_mask:0xf
v_dot2c_f32_bf16_dpp v51, v40, v19 row_newbcast:8 row_mask:0xf bank_mask:0xf
v_dot2c_f32_bf16_dpp v44, v36, v20 row_newbcast:9 row_mask:0xf bank_mask:0xf
v_dot2c_f32_bf16_dpp v45, v40, v20 row_newbcast:9 row_mask:0xf bank_mask:0xf
v_dot2c_f32_bf16_dpp v46, v36, v21 row_newbcast:9 row_mask:0xf bank_mask:0xf
v_dot2c_f32_bf16_dpp v47, v40, v21 row_newbcast:9 row_mask:0xf bank_mask:0xf
v_dot2c_f32_bf16_dpp v48, v36, v22 row_newbcast:9 row_mask:0xf bank_mask:0xf
v_dot2c_f32_bf16_dpp v49, v40, v22 row_newbcast:9 row_mask:0xf bank_mask:0xf
v_dot2c_f32_bf16_dpp v50, v36, v23 row_newbcast:9 row_mask:0xf bank_mask:0xf
v_dot2c_f32_bf16_dpp v51, v40, v23 row_newbcast:9 row_mask:0xf bank_mask:0xf
v_dot2c_f32_bf16_dpp v44, v36, v24 row_newbcast:10 row_mask:0xf bank_mask:0xf
v_dot2c_f32_bf16_dpp v45, v40, v24 row_newbcast:10 row_mask:0xf bank_mask:0xf
v_dot2c_f32_bf16_dpp v46, v36, v25 row_newbcast:10 row_mask:0xf bank_mask:0xf
v_dot2c_f32_bf16_dpp v47, v40, v25 row_newbcast:10 row_mask:0xf bank_mask:0xf
v_dot2c_f32_bf16_dpp v48, v36, v26 row_newbcast:10 row_mask:0xf bank_mask:0xf
v_dot2c_f32_bf16_dpp v49, v40, v26 row_newbcast:10 row_mask:0xf bank_mask:0xf
v_dot2c_f32_bf16_dpp v50, v36, v27 row_newbcast:10 row_mask:0xf bank_mask:0xf
v_dot2c_f32_bf16_dpp v51, v40, v27 row_newbcast:10 row_mask:0xf bank_mask:0xf
v_dot2c_f32_bf16_dpp v44, v36, v28 row_newbcast:11 row_mask:0xf bank_mask:0xf
v_dot2c_f32_bf16_dpp v45, v40, v28 row_newbcast:11 row_mask:0xf bank_mask:0xf
v_dot2c_f32_bf16_dpp v46, v36, v29 row_newbcast:11 row_mask:0xf bank_mask:0xf
v_dot2c_f32_bf16_dpp v47, v40, v29 row_newbcast:11 row_mask:0xf bank_mask:0xf
v_dot2c_f32_bf16_dpp v48, v36, v30 row_newbcast:11 row_mask:0xf bank_mask:0xf
v_dot2c_f32_bf16_dpp v49, v40, v30 row_newbcast:11 row_mask:0xf bank_mask:0xf
v_dot2c_f32_bf16_dpp v50, v36, v31 row_newbcast:11 row_mask:0xf bank_mask:0xf
v_dot2c_f32_bf16_dpp v51, v40, v31 row_newbcast:11 row_mask:0xf bank_mask:0xf
s_waitcnt vmcnt(28)
ds_read_b128 v[16:19], v52 offset:28672
ds_read_b128 v[20:23], v52 offset:29696
ds_read_b128 v[24:27], v52 offset:30720
ds_read_b128 v[28:31], v52 offset:31744
s_waitcnt vmcnt(11)
s_add_u32 s73, s72, 180224
s_and_b32 s73, s73, 0x3ffff
s_add_u32 s73, s73, s71
buffer_load_dwordx4 v[176:179], v1, s[32:35], s73 offen nt
s_waitcnt vmcnt(11)
s_add_u32 s73, s72, 184320
s_and_b32 s73, s73, 0x3ffff
s_add_u32 s73, s73, s71
buffer_load_dwordx4 v[180:183], v1, s[32:35], s73 offen nt
s_waitcnt vmcnt(11)
s_add_u32 s73, s72, 188416
s_and_b32 s73, s73, 0x3ffff
s_add_u32 s73, s73, s71
buffer_load_dwordx4 v[184:187], v1, s[32:35], s73 offen nt
s_waitcnt vmcnt(11)
s_add_u32 s73, s72, 192512
s_and_b32 s73, s73, 0x3ffff
s_add_u32 s73, s73, s71
buffer_load_dwordx4 v[188:191], v1, s[32:35], s73 offen nt
s_waitcnt lgkmcnt(0)
v_dot2c_f32_bf16_dpp v44, v36, v16 row_newbcast:12 row_mask:0xf bank_mask:0xf
v_dot2c_f32_bf16_dpp v45, v40, v16 row_newbcast:12 row_mask:0xf bank_mask:0xf
v_dot2c_f32_bf16_dpp v46, v36, v17 row_newbcast:12 row_mask:0xf bank_mask:0xf
v_dot2c_f32_bf16_dpp v47, v40, v17 row_newbcast:12 row_mask:0xf bank_mask:0xf
v_dot2c_f32_bf16_dpp v48, v36, v18 row_newbcast:12 row_mask:0xf bank_mask:0xf
v_dot2c_f32_bf16_dpp v49, v40, v18 row_newbcast:12 row_mask:0xf bank_mask:0xf
v_dot2c_f32_bf16_dpp v50, v36, v19 row_newbcast:12 row_mask:0xf bank_mask:0xf
v_dot2c_f32_bf16_dpp v51, v40, v19 row_newbcast:12 row_mask:0xf bank_mask:0xf
v_dot2c_f32_bf16_dpp v44, v36, v20 row_newbcast:13 row_mask:0xf bank_mask:0xf
v_dot2c_f32_bf16_dpp v45, v40, v20 row_newbcast:13 row_mask:0xf bank_mask:0xf
v_dot2c_f32_bf16_dpp v46, v36, v21 row_newbcast:13 row_mask:0xf bank_mask:0xf
v_dot2c_f32_bf16_dpp v47, v40, v21 row_newbcast:13 row_mask:0xf bank_mask:0xf
v_dot2c_f32_bf16_dpp v48, v36, v22 row_newbcast:13 row_mask:0xf bank_mask:0xf
v_dot2c_f32_bf16_dpp v49, v40, v22 row_newbcast:13 row_mask:0xf bank_mask:0xf
v_dot2c_f32_bf16_dpp v50, v36, v23 row_newbcast:13 row_mask:0xf bank_mask:0xf
v_dot2c_f32_bf16_dpp v51, v40, v23 row_newbcast:13 row_mask:0xf bank_mask:0xf
v_dot2c_f32_bf16_dpp v44, v36, v24 row_newbcast:14 row_mask:0xf bank_mask:0xf
v_dot2c_f32_bf16_dpp v45, v40, v24 row_newbcast:14 row_mask:0xf bank_mask:0xf
v_dot2c_f32_bf16_dpp v46, v36, v25 row_newbcast:14 row_mask:0xf bank_mask:0xf
v_dot2c_f32_bf16_dpp v47, v40, v25 row_newbcast:14 row_mask:0xf bank_mask:0xf
v_dot2c_f32_bf16_dpp v48, v36, v26 row_newbcast:14 row_mask:0xf bank_mask:0xf
v_dot2c_f32_bf16_dpp v49, v40, v26 row_newbcast:14 row_mask:0xf bank_mask:0xf
v_dot2c_f32_bf16_dpp v50, v36, v27 row_newbcast:14 row_mask:0xf bank_mask:0xf
v_dot2c_f32_bf16_dpp v51, v40, v27 row_newbcast:14 row_mask:0xf bank_mask:0xf
v_dot2c_f32_bf16_dpp v44, v36, v28 row_newbcast:15 row_mask:0xf bank_mask:0xf
v_dot2c_f32_bf16_dpp v45, v40, v28 row_newbcast:15 row_mask:0xf bank_mask:0xf
v_dot2c_f32_bf16_dpp v46, v36, v29 row_newbcast:15 row_mask:0xf bank_mask:0xf
v_dot2c_f32_bf16_dpp v47, v40, v29 row_newbcast:15 row_mask:0xf bank_mask:0xf
v_dot2c_f32_bf16_dpp v48, v36, v30 row_newbcast:15 row_mask:0xf bank_mask:0xf
v_dot2c_f32_bf16_dpp v49, v40, v30 row_newbcast:15 row_mask:0xf bank_mask:0xf
v_dot2c_f32_bf16_dpp v50, v36, v31 row_newbcast:15 row_mask:0xf bank_mask:0xf
v_dot2c_f32_bf16_dpp v51, v40, v31 row_newbcast:15 row_mask:0xf bank_mask:0xf
s_waitcnt vmcnt(28)
v_dot2c_f32_bf16_dpp v44, v37, v64 row_newbcast:0 row_mask:0xf bank_mask:0xf
v_dot2c_f32_bf16_dpp v45, v41, v64 row_newbcast:0 row_mask:0xf bank_mask:0xf
v_dot2c_f32_bf16_dpp v46, v37, v65 row_newbcast:0 row_mask:0xf bank_mask:0xf
v_dot2c_f32_bf16_dpp v47, v41, v65 row_newbcast:0 row_mask:0xf bank_mask:0xf
v_dot2c_f32_bf16_dpp v48, v37, v66 row_newbcast:0 row_mask:0xf bank_mask:0xf
v_dot2c_f32_bf16_dpp v49, v41, v66 row_newbcast:0 row_mask:0xf bank_mask:0xf
v_dot2c_f32_bf16_dpp v50, v37, v67 row_newbcast:0 row_mask:0xf bank_mask:0xf
v_dot2c_f32_bf16_dpp v51, v41, v67 row_newbcast:0 row_mask:0xf bank_mask:0xf
v_dot2c_f32_bf16_dpp v44, v37, v68 row_newbcast:1 row_mask:0xf bank_mask:0xf
v_dot2c_f32_bf16_dpp v45, v41, v68 row_newbcast:1 row_mask:0xf bank_mask:0xf
v_dot2c_f32_bf16_dpp v46, v37, v69 row_newbcast:1 row_mask:0xf bank_mask:0xf
v_dot2c_f32_bf16_dpp v47, v41, v69 row_newbcast:1 row_mask:0xf bank_mask:0xf
v_dot2c_f32_bf16_dpp v48, v37, v70 row_newbcast:1 row_mask:0xf bank_mask:0xf
v_dot2c_f32_bf16_dpp v49, v41, v70 row_newbcast:1 row_mask:0xf bank_mask:0xf
v_dot2c_f32_bf16_dpp v50, v37, v71 row_newbcast:1 row_mask:0xf bank_mask:0xf
v_dot2c_f32_bf16_dpp v51, v41, v71 row_newbcast:1 row_mask:0xf bank_mask:0xf
v_dot2c_f32_bf16_dpp v44, v37, v72 row_newbcast:2 row_mask:0xf bank_mask:0xf
v_dot2c_f32_bf16_dpp v45, v41, v72 row_newbcast:2 row_mask:0xf bank_mask:0xf
v_dot2c_f32_bf16_dpp v46, v37, v73 row_newbcast:2 row_mask:0xf bank_mask:0xf
v_dot2c_f32_bf16_dpp v47, v41, v73 row_newbcast:2 row_mask:0xf bank_mask:0xf
v_dot2c_f32_bf16_dpp v48, v37, v74 row_newbcast:2 row_mask:0xf bank_mask:0xf
v_dot2c_f32_bf16_dpp v49, v41, v74 row_newbcast:2 row_mask:0xf bank_mask:0xf
v_dot2c_f32_bf16_dpp v50, v37, v75 row_newbcast:2 row_mask:0xf bank_mask:0xf
v_dot2c_f32_bf16_dpp v51, v41, v75 row_newbcast:2 row_mask:0xf bank_mask:0xf
v_dot2c_f32_bf16_dpp v44, v37, v76 row_newbcast:3 row_mask:0xf bank_mask:0xf
v_dot2c_f32_bf16_dpp v45, v41, v76 row_newbcast:3 row_mask:0xf bank_mask:0xf
v_dot2c_f32_bf16_dpp v46, v37, v77 row_newbcast:3 row_mask:0xf bank_mask:0xf
v_dot2c_f32_bf16_dpp v47, v41, v77 row_newbcast:3 row_mask:0xf bank_mask:0xf
v_dot2c_f32_bf16_dpp v48, v37, v78 row_newbcast:3 row_mask:0xf bank_mask:0xf
v_dot2c_f32_bf16_dpp v49, v41, v78 row_newbcast:3 row_mask:0xf bank_mask:0xf
v_dot2c_f32_bf16_dpp v50, v37, v79 row_newbcast:3 row_mask:0xf bank_mask:0xf
v_dot2c_f32_bf16_dpp v51, v41, v79 row_newbcast:3 row_mask:0xf bank_mask:0xf
s_waitcnt vmcnt(24)
v_dot2c_f32_bf16_dpp v44, v37, v80 row_newbcast:4 row_mask:0xf bank_mask:0xf
v_dot2c_f32_bf16_dpp v45, v41, v80 row_newbcast:4 row_mask:0xf bank_mask:0xf
v_dot2c_f32_bf16_dpp v46, v37, v81 row_newbcast:4 row_mask:0xf bank_mask:0xf
v_dot2c_f32_bf16_dpp v47, v41, v81 row_newbcast:4 row_mask:0xf bank_mask:0xf
v_dot2c_f32_bf16_dpp v48, v37, v82 row_newbcast:4 row_mask:0xf bank_mask:0xf
v_dot2c_f32_bf16_dpp v49, v41, v82 row_newbcast:4 row_mask:0xf bank_mask:0xf
v_dot2c_f32_bf16_dpp v50, v37, v83 row_newbcast:4 row_mask:0xf bank_mask:0xf
v_dot2c_f32_bf16_dpp v51, v41, v83 row_newbcast:4 row_mask:0xf bank_mask:0xf
v_dot2c_f32_bf16_dpp v44, v37, v84 row_newbcast:5 row_mask:0xf bank_mask:0xf
v_dot2c_f32_bf16_dpp v45, v41, v84 row_newbcast:5 row_mask:0xf bank_mask:0xf
v_dot2c_f32_bf16_dpp v46, v37, v85 row_newbcast:5 row_mask:0xf bank_mask:0xf
v_dot2c_f32_bf16_dpp v47, v41, v85 row_newbcast:5 row_mask:0xf bank_mask:0xf
v_dot2c_f32_bf16_dpp v48, v37, v86 row_newbcast:5 row_mask:0xf bank_mask:0xf
v_dot2c_f32_bf16_dpp v49, v41, v86 row_newbcast:5 row_mask:0xf bank_mask:0xf
v_dot2c_f32_bf16_dpp v50, v37, v87 row_newbcast:5 row_mask:0xf bank_mask:0xf
v_dot2c_f32_bf16_dpp v51, v41, v87 row_newbcast:5 row_mask:0xf bank_mask:0xf
v_dot2c_f32_bf16_dpp v44, v37, v88 row_newbcast:6 row_mask:0xf bank_mask:0xf
v_dot2c_f32_bf16_dpp v45, v41, v88 row_newbcast:6 row_mask:0xf bank_mask:0xf
v_dot2c_f32_bf16_dpp v46, v37, v89 row_newbcast:6 row_mask:0xf bank_mask:0xf
v_dot2c_f32_bf16_dpp v47, v41, v89 row_newbcast:6 row_mask:0xf bank_mask:0xf
v_dot2c_f32_bf16_dpp v48, v37, v90 row_newbcast:6 row_mask:0xf bank_mask:0xf
v_dot2c_f32_bf16_dpp v49, v41, v90 row_newbcast:6 row_mask:0xf bank_mask:0xf
v_dot2c_f32_bf16_dpp v50, v37, v91 row_newbcast:6 row_mask:0xf bank_mask:0xf
v_dot2c_f32_bf16_dpp v51, v41, v91 row_newbcast:6 row_mask:0xf bank_mask:0xf
v_dot2c_f32_bf16_dpp v44, v37, v92 row_newbcast:7 row_mask:0xf bank_mask:0xf
v_dot2c_f32_bf16_dpp v45, v41, v92 row_newbcast:7 row_mask:0xf bank_mask:0xf
v_dot2c_f32_bf16_dpp v46, v37, v93 row_newbcast:7 row_mask:0xf bank_mask:0xf
v_dot2c_f32_bf16_dpp v47, v41, v93 row_newbcast:7 row_mask:0xf bank_mask:0xf
v_dot2c_f32_bf16_dpp v48, v37, v94 row_newbcast:7 row_mask:0xf bank_mask:0xf
v_dot2c_f32_bf16_dpp v49, v41, v94 row_newbcast:7 row_mask:0xf bank_mask:0xf
v_dot2c_f32_bf16_dpp v50, v37, v95 row_newbcast:7 row_mask:0xf bank_mask:0xf
v_dot2c_f32_bf16_dpp v51, v41, v95 row_newbcast:7 row_mask:0xf bank_mask:0xf
s_waitcnt vmcnt(11)
s_add_u32 s73, s72, 196608
s_and_b32 s73, s73, 0x3ffff
s_add_u32 s73, s73, s71
buffer_load_dwordx4 v[192:195], v1, s[32:35], s73 offen nt
s_waitcnt vmcnt(11)
s_add_u32 s73, s72, 200704
s_and_b32 s73, s73, 0x3ffff
s_add_u32 s73, s73, s71
buffer_load_dwordx4 v[196:199], v1, s[32:35], s73 offen nt
s_waitcnt vmcnt(11)
s_add_u32 s73, s72, 204800
s_and_b32 s73, s73, 0x3ffff
s_add_u32 s73, s73, s71
buffer_load_dwordx4 v[200:203], v1, s[32:35], s73 offen nt
s_waitcnt vmcnt(11)
s_add_u32 s73, s72, 208896
s_and_b32 s73, s73, 0x3ffff
s_add_u32 s73, s73, s71
buffer_load_dwordx4 v[204:207], v1, s[32:35], s73 offen nt
s_waitcnt vmcnt(24)
v_dot2c_f32_bf16_dpp v44, v37, v96 row_newbcast:8 row_mask:0xf bank_mask:0xf
v_dot2c_f32_bf16_dpp v45, v41, v96 row_newbcast:8 row_mask:0xf bank_mask:0xf
v_dot2c_f32_bf16_dpp v46, v37, v97 row_newbcast:8 row_mask:0xf bank_mask:0xf
v_dot2c_f32_bf16_dpp v47, v41, v97 row_newbcast:8 row_mask:0xf bank_mask:0xf
v_dot2c_f32_bf16_dpp v48, v37, v98 row_newbcast:8 row_mask:0xf bank_mask:0xf
v_dot2c_f32_bf16_dpp v49, v41, v98 row_newbcast:8 row_mask:0xf bank_mask:0xf
v_dot2c_f32_bf16_dpp v50, v37, v99 row_newbcast:8 row_mask:0xf bank_mask:0xf
v_dot2c_f32_bf16_dpp v51, v41, v99 row_newbcast:8 row_mask:0xf bank_mask:0xf
v_dot2c_f32_bf16_dpp v44, v37, v100 row_newbcast:9 row_mask:0xf bank_mask:0xf
v_dot2c_f32_bf16_dpp v45, v41, v100 row_newbcast:9 row_mask:0xf bank_mask:0xf
v_dot2c_f32_bf16_dpp v46, v37, v101 row_newbcast:9 row_mask:0xf bank_mask:0xf
v_dot2c_f32_bf16_dpp v47, v41, v101 row_newbcast:9 row_mask:0xf bank_mask:0xf
v_dot2c_f32_bf16_dpp v48, v37, v102 row_newbcast:9 row_mask:0xf bank_mask:0xf
v_dot2c_f32_bf16_dpp v49, v41, v102 row_newbcast:9 row_mask:0xf bank_mask:0xf
v_dot2c_f32_bf16_dpp v50, v37, v103 row_newbcast:9 row_mask:0xf bank_mask:0xf
v_dot2c_f32_bf16_dpp v51, v41, v103 row_newbcast:9 row_mask:0xf bank_mask:0xf
v_dot2c_f32_bf16_dpp v44, v37, v104 row_newbcast:10 row_mask:0xf bank_mask:0xf
v_dot2c_f32_bf16_dpp v45, v41, v104 row_newbcast:10 row_mask:0xf bank_mask:0xf
v_dot2c_f32_bf16_dpp v46, v37, v105 row_newbcast:10 row_mask:0xf bank_mask:0xf
v_dot2c_f32_bf16_dpp v47, v41, v105 row_newbcast:10 row_mask:0xf bank_mask:0xf
v_dot2c_f32_bf16_dpp v48, v37, v106 row_newbcast:10 row_mask:0xf bank_mask:0xf
v_dot2c_f32_bf16_dpp v49, v41, v106 row_newbcast:10 row_mask:0xf bank_mask:0xf
v_dot2c_f32_bf16_dpp v50, v37, v107 row_newbcast:10 row_mask:0xf bank_mask:0xf
v_dot2c_f32_bf16_dpp v51, v41, v107 row_newbcast:10 row_mask:0xf bank_mask:0xf
v_dot2c_f32_bf16_dpp v44, v37, v108 row_newbcast:11 row_mask:0xf bank_mask:0xf
v_dot2c_f32_bf16_dpp v45, v41, v108 row_newbcast:11 row_mask:0xf bank_mask:0xf
v_dot2c_f32_bf16_dpp v46, v37, v109 row_newbcast:11 row_mask:0xf bank_mask:0xf
v_dot2c_f32_bf16_dpp v47, v41, v109 row_newbcast:11 row_mask:0xf bank_mask:0xf
v_dot2c_f32_bf16_dpp v48, v37, v110 row_newbcast:11 row_mask:0xf bank_mask:0xf
v_dot2c_f32_bf16_dpp v49, v41, v110 row_newbcast:11 row_mask:0xf bank_mask:0xf
v_dot2c_f32_bf16_dpp v50, v37, v111 row_newbcast:11 row_mask:0xf bank_mask:0xf
v_dot2c_f32_bf16_dpp v51, v41, v111 row_newbcast:11 row_mask:0xf bank_mask:0xf
s_waitcnt vmcnt(20)
v_dot2c_f32_bf16_dpp v44, v37, v112 row_newbcast:12 row_mask:0xf bank_mask:0xf
v_dot2c_f32_bf16_dpp v45, v41, v112 row_newbcast:12 row_mask:0xf bank_mask:0xf
v_dot2c_f32_bf16_dpp v46, v37, v113 row_newbcast:12 row_mask:0xf bank_mask:0xf
v_dot2c_f32_bf16_dpp v47, v41, v113 row_newbcast:12 row_mask:0xf bank_mask:0xf
v_dot2c_f32_bf16_dpp v48, v37, v114 row_newbcast:12 row_mask:0xf bank_mask:0xf
v_dot2c_f32_bf16_dpp v49, v41, v114 row_newbcast:12 row_mask:0xf bank_mask:0xf
v_dot2c_f32_bf16_dpp v50, v37, v115 row_newbcast:12 row_mask:0xf bank_mask:0xf
v_dot2c_f32_bf16_dpp v51, v41, v115 row_newbcast:12 row_mask:0xf bank_mask:0xf
v_dot2c_f32_bf16_dpp v44, v37, v116 row_newbcast:13 row_mask:0xf bank_mask:0xf
v_dot2c_f32_bf16_dpp v45, v41, v116 row_newbcast:13 row_mask:0xf bank_mask:0xf
v_dot2c_f32_bf16_dpp v46, v37, v117 row_newbcast:13 row_mask:0xf bank_mask:0xf
v_dot2c_f32_bf16_dpp v47, v41, v117 row_newbcast:13 row_mask:0xf bank_mask:0xf
v_dot2c_f32_bf16_dpp v48, v37, v118 row_newbcast:13 row_mask:0xf bank_mask:0xf
v_dot2c_f32_bf16_dpp v49, v41, v118 row_newbcast:13 row_mask:0xf bank_mask:0xf
v_dot2c_f32_bf16_dpp v50, v37, v119 row_newbcast:13 row_mask:0xf bank_mask:0xf
v_dot2c_f32_bf16_dpp v51, v41, v119 row_newbcast:13 row_mask:0xf bank_mask:0xf
v_dot2c_f32_bf16_dpp v44, v37, v120 row_newbcast:14 row_mask:0xf bank_mask:0xf
v_dot2c_f32_bf16_dpp v45, v41, v120 row_newbcast:14 row_mask:0xf bank_mask:0xf
v_dot2c_f32_bf16_dpp v46, v37, v121 row_newbcast:14 row_mask:0xf bank_mask:0xf
v_dot2c_f32_bf16_dpp v47, v41, v121 row_newbcast:14 row_mask:0xf bank_mask:0xf
v_dot2c_f32_bf16_dpp v48, v37, v122 row_newbcast:14 row_mask:0xf bank_mask:0xf
v_dot2c_f32_bf16_dpp v49, v41, v122 row_newbcast:14 row_mask:0xf bank_mask:0xf
v_dot2c_f32_bf16_dpp v50, v37, v123 row_newbcast:14 row_mask:0xf bank_mask:0xf
v_dot2c_f32_bf16_dpp v51, v41, v123 row_newbcast:14 row_mask:0xf bank_mask:0xf
v_dot2c_f32_bf16_dpp v44, v37, v124 row_newbcast:15 row_mask:0xf bank_mask:0xf
v_dot2c_f32_bf16_dpp v45, v41, v124 row_newbcast:15 row_mask:0xf bank_mask:0xf
v_dot2c_f32_bf16_dpp v46, v37, v125 row_newbcast:15 row_mask:0xf bank_mask:0xf
v_dot2c_f32_bf16_dpp v47, v41, v125 row_newbcast:15 row_mask:0xf bank_mask:0xf
v_dot2c_f32_bf16_dpp v48, v37, v126 row_newbcast:15 row_mask:0xf bank_mask:0xf
v_dot2c_f32_bf16_dpp v49, v41, v126 row_newbcast:15 row_mask:0xf bank_mask:0xf
v_dot2c_f32_bf16_dpp v50, v37, v127 row_newbcast:15 row_mask:0xf bank_mask:0xf
v_dot2c_f32_bf16_dpp v51, v41, v127 row_newbcast:15 row_mask:0xf bank_mask:0xf
s_waitcnt vmcnt(11)
s_add_u32 s73, s72, 212992
s_and_b32 s73, s73, 0x3ffff
s_add_u32 s73, s73, s71
buffer_load_dwordx4 v[208:211], v1, s[32:35], s73 offen nt
s_waitcnt vmcnt(11)
s_add_u32 s73, s72, 217088
s_and_b32 s73, s73, 0x3ffff
s_add_u32 s73, s73, s71
buffer_load_dwordx4 v[212:215], v1, s[32:35], s73 offen nt
s_waitcnt vmcnt(11)
s_add_u32 s73, s72, 221184
s_and_b32 s73, s73, 0x3ffff
s_add_u32 s73, s73, s71
buffer_load_dwordx4 v[216:219], v1, s[32:35], s73 offen nt
s_waitcnt vmcnt(11)
s_add_u32 s73, s72, 225280
s_and_b32 s73, s73, 0x3ffff
s_add_u32 s73, s73, s71
buffer_load_dwordx4 v[220:223], v1, s[32:35], s73 offen nt
s_waitcnt vmcnt(20)
v_dot2c_f32_bf16_dpp v44, v38, v128 row_newbcast:0 row_mask:0xf bank_mask:0xf
v_dot2c_f32_bf16_dpp v45, v42, v128 row_newbcast:0 row_mask:0xf bank_mask:0xf
v_dot2c_f32_bf16_dpp v46, v38, v129 row_newbcast:0 row_mask:0xf bank_mask:0xf
v_dot2c_f32_bf16_dpp v47, v42, v129 row_newbcast:0 row_mask:0xf bank_mask:0xf
v_dot2c_f32_bf16_dpp v48, v38, v130 row_newbcast:0 row_mask:0xf bank_mask:0xf
v_dot2c_f32_bf16_dpp v49, v42, v130 row_newbcast:0 row_mask:0xf bank_mask:0xf
v_dot2c_f32_bf16_dpp v50, v38, v131 row_newbcast:0 row_mask:0xf bank_mask:0xf
v_dot2c_f32_bf16_dpp v51, v42, v131 row_newbcast:0 row_mask:0xf bank_mask:0xf
v_dot2c_f32_bf16_dpp v44, v38, v132 row_newbcast:1 row_mask:0xf bank_mask:0xf
v_dot2c_f32_bf16_dpp v45, v42, v132 row_newbcast:1 row_mask:0xf bank_mask:0xf
v_dot2c_f32_bf16_dpp v46, v38, v133 row_newbcast:1 row_mask:0xf bank_mask:0xf
v_dot2c_f32_bf16_dpp v47, v42, v133 row_newbcast:1 row_mask:0xf bank_mask:0xf
v_dot2c_f32_bf16_dpp v48, v38, v134 row_newbcast:1 row_mask:0xf bank_mask:0xf
v_dot2c_f32_bf16_dpp v49, v42, v134 row_newbcast:1 row_mask:0xf bank_mask:0xf
v_dot2c_f32_bf16_dpp v50, v38, v135 row_newbcast:1 row_mask:0xf bank_mask:0xf
v_dot2c_f32_bf16_dpp v51, v42, v135 row_newbcast:1 row_mask:0xf bank_mask:0xf
v_dot2c_f32_bf16_dpp v44, v38, v136 row_newbcast:2 row_mask:0xf bank_mask:0xf
v_dot2c_f32_bf16_dpp v45, v42, v136 row_newbcast:2 row_mask:0xf bank_mask:0xf
v_dot2c_f32_bf16_dpp v46, v38, v137 row_newbcast:2 row_mask:0xf bank_mask:0xf
v_dot2c_f32_bf16_dpp v47, v42, v137 row_newbcast:2 row_mask:0xf bank_mask:0xf
v_dot2c_f32_bf16_dpp v48, v38, v138 row_newbcast:2 row_mask:0xf bank_mask:0xf
v_dot2c_f32_bf16_dpp v49, v42, v138 row_newbcast:2 row_mask:0xf bank_mask:0xf
v_dot2c_f32_bf16_dpp v50, v38, v139 row_newbcast:2 row_mask:0xf bank_mask:0xf
v_dot2c_f32_bf16_dpp v51, v42, v139 row_newbcast:2 row_mask:0xf bank_mask:0xf
v_dot2c_f32_bf16_dpp v44, v38, v140 row_newbcast:3 row_mask:0xf bank_mask:0xf
v_dot2c_f32_bf16_dpp v45, v42, v140 row_newbcast:3 row_mask:0xf bank_mask:0xf
v_dot2c_f32_bf16_dpp v46, v38, v141 row_newbcast:3 row_mask:0xf bank_mask:0xf
v_dot2c_f32_bf16_dpp v47, v42, v141 row_newbcast:3 row_mask:0xf bank_mask:0xf
v_dot2c_f32_bf16_dpp v48, v38, v142 row_newbcast:3 row_mask:0xf bank_mask:0xf
v_dot2c_f32_bf16_dpp v49, v42, v142 row_newbcast:3 row_mask:0xf bank_mask:0xf
v_dot2c_f32_bf16_dpp v50, v38, v143 row_newbcast:3 row_mask:0xf bank_mask:0xf
v_dot2c_f32_bf16_dpp v51, v42, v143 row_newbcast:3 row_mask:0xf bank_mask:0xf
s_waitcnt vmcnt(16)
v_dot2c_f32_bf16_dpp v44, v38, v144 row_newbcast:4 row_mask:0xf bank_mask:0xf
v_dot2c_f32_bf16_dpp v45, v42, v144 row_newbcast:4 row_mask:0xf bank_mask:0xf
v_dot2c_f32_bf16_dpp v46, v38, v145 row_newbcast:4 row_mask:0xf bank_mask:0xf
v_dot2c_f32_bf16_dpp v47, v42, v145 row_newbcast:4 row_mask:0xf bank_mask:0xf
v_dot2c_f32_bf16_dpp v48, v38, v146 row_newbcast:4 row_mask:0xf bank_mask:0xf
v_dot2c_f32_bf16_dpp v49, v42, v146 row_newbcast:4 row_mask:0xf bank_mask:0xf
v_dot2c_f32_bf16_dpp v50, v38, v147 row_newbcast:4 row_mask:0xf bank_mask:0xf
v_dot2c_f32_bf16_dpp v51, v42, v147 row_newbcast:4 row_mask:0xf bank_mask:0xf
v_dot2c_f32_bf16_dpp v44, v38, v148 row_newbcast:5 row_mask:0xf bank_mask:0xf
v_dot2c_f32_bf16_dpp v45, v42, v148 row_newbcast:5 row_mask:0xf bank_mask:0xf
v_dot2c_f32_bf16_dpp v46, v38, v149 row_newbcast:5 row_mask:0xf bank_mask:0xf
v_dot2c_f32_bf16_dpp v47, v42, v149 row_newbcast:5 row_mask:0xf bank_mask:0xf
v_dot2c_f32_bf16_dpp v48, v38, v150 row_newbcast:5 row_mask:0xf bank_mask:0xf
v_dot2c_f32_bf16_dpp v49, v42, v150 row_newbcast:5 row_mask:0xf bank_mask:0xf
v_dot2c_f32_bf16_dpp v50, v38, v151 row_newbcast:5 row_mask:0xf bank_mask:0xf
v_dot2c_f32_bf16_dpp v51, v42, v151 row_newbcast:5 row_mask:0xf bank_mask:0xf
v_dot2c_f32_bf16_dpp v44, v38, v152 row_newbcast:6 row_mask:0xf bank_mask:0xf
v_dot2c_f32_bf16_dpp v45, v42, v152 row_newbcast:6 row_mask:0xf bank_mask:0xf
v_dot2c_f32_bf16_dpp v46, v38, v153 row_newbcast:6 row_mask:0xf bank_mask:0xf
v_dot2c_f32_bf16_dpp v47, v42, v153 row_newbcast:6 row_mask:0xf bank_mask:0xf
v_dot2c_f32_bf16_dpp v48, v38, v154 row_newbcast:6 row_mask:0xf bank_mask:0xf
v_dot2c_f32_bf16_dpp v49, v42, v154 row_newbcast:6 row_mask:0xf bank_mask:0xf
v_dot2c_f32_bf16_dpp v50, v38, v155 row_newbcast:6 row_mask:0xf bank_mask:0xf
v_dot2c_f32_bf16_dpp v51, v42, v155 row_newbcast:6 row_mask:0xf bank_mask:0xf
v_dot2c_f32_bf16_dpp v44, v38, v156 row_newbcast:7 row_mask:0xf bank_mask:0xf
v_dot2c_f32_bf16_dpp v45, v42, v156 row_newbcast:7 row_mask:0xf bank_mask:0xf
v_dot2c_f32_bf16_dpp v46, v38, v157 row_newbcast:7 row_mask:0xf bank_mask:0xf
v_dot2c_f32_bf16_dpp v47, v42, v157 row_newbcast:7 row_mask:0xf bank_mask:0xf
v_dot2c_f32_bf16_dpp v48, v38, v158 row_newbcast:7 row_mask:0xf bank_mask:0xf
v_dot2c_f32_bf16_dpp v49, v42, v158 row_newbcast:7 row_mask:0xf bank_mask:0xf
v_dot2c_f32_bf16_dpp v50, v38, v159 row_newbcast:7 row_mask:0xf bank_mask:0xf
v_dot2c_f32_bf16_dpp v51, v42, v159 row_newbcast:7 row_mask:0xf bank_mask:0xf
s_waitcnt vmcnt(11)
s_add_u32 s73, s72, 229376
s_and_b32 s73, s73, 0x3ffff
s_add_u32 s73, s73, s71
buffer_load_dwordx4 v[224:227], v1, s[32:35], s73 offen nt
s_waitcnt vmcnt(11)
s_add_u32 s73, s72, 233472
s_and_b32 s73, s73, 0x3ffff
s_add_u32 s73, s73, s71
buffer_load_dwordx4 v[228:231], v1, s[32:35], s73 offen nt
s_waitcnt vmcnt(11)
s_add_u32 s73, s72, 237568
s_and_b32 s73, s73, 0x3ffff
s_add_u32 s73, s73, s71
buffer_load_dwordx4 v[232:235], v1, s[32:35], s73 offen nt
s_waitcnt vmcnt(11)
s_add_u32 s73, s72, 241664
s_and_b32 s73, s73, 0x3ffff
s_add_u32 s73, s73, s71
buffer_load_dwordx4 v[236:239], v1, s[32:35], s73 offen nt
s_waitcnt vmcnt(16)
v_dot2c_f32_bf16_dpp v44, v38, v160 row_newbcast:8 row_mask:0xf bank_mask:0xf
v_dot2c_f32_bf16_dpp v45, v42, v160 row_newbcast:8 row_mask:0xf bank_mask:0xf
v_dot2c_f32_bf16_dpp v46, v38, v161 row_newbcast:8 row_mask:0xf bank_mask:0xf
v_dot2c_f32_bf16_dpp v47, v42, v161 row_newbcast:8 row_mask:0xf bank_mask:0xf
v_dot2c_f32_bf16_dpp v48, v38, v162 row_newbcast:8 row_mask:0xf bank_mask:0xf
v_dot2c_f32_bf16_dpp v49, v42, v162 row_newbcast:8 row_mask:0xf bank_mask:0xf
v_dot2c_f32_bf16_dpp v50, v38, v163 row_newbcast:8 row_mask:0xf bank_mask:0xf
v_dot2c_f32_bf16_dpp v51, v42, v163 row_newbcast:8 row_mask:0xf bank_mask:0xf
v_dot2c_f32_bf16_dpp v44, v38, v164 row_newbcast:9 row_mask:0xf bank_mask:0xf
v_dot2c_f32_bf16_dpp v45, v42, v164 row_newbcast:9 row_mask:0xf bank_mask:0xf
v_dot2c_f32_bf16_dpp v46, v38, v165 row_newbcast:9 row_mask:0xf bank_mask:0xf
v_dot2c_f32_bf16_dpp v47, v42, v165 row_newbcast:9 row_mask:0xf bank_mask:0xf
v_dot2c_f32_bf16_dpp v48, v38, v166 row_newbcast:9 row_mask:0xf bank_mask:0xf
v_dot2c_f32_bf16_dpp v49, v42, v166 row_newbcast:9 row_mask:0xf bank_mask:0xf
v_dot2c_f32_bf16_dpp v50, v38, v167 row_newbcast:9 row_mask:0xf bank_mask:0xf
v_dot2c_f32_bf16_dpp v51, v42, v167 row_newbcast:9 row_mask:0xf bank_mask:0xf
v_dot2c_f32_bf16_dpp v44, v38, v168 row_newbcast:10 row_mask:0xf bank_mask:0xf
v_dot2c_f32_bf16_dpp v45, v42, v168 row_newbcast:10 row_mask:0xf bank_mask:0xf
v_dot2c_f32_bf16_dpp v46, v38, v169 row_newbcast:10 row_mask:0xf bank_mask:0xf
v_dot2c_f32_bf16_dpp v47, v42, v169 row_newbcast:10 row_mask:0xf bank_mask:0xf
v_dot2c_f32_bf16_dpp v48, v38, v170 row_newbcast:10 row_mask:0xf bank_mask:0xf
v_dot2c_f32_bf16_dpp v49, v42, v170 row_newbcast:10 row_mask:0xf bank_mask:0xf
v_dot2c_f32_bf16_dpp v50, v38, v171 row_newbcast:10 row_mask:0xf bank_mask:0xf
v_dot2c_f32_bf16_dpp v51, v42, v171 row_newbcast:10 row_mask:0xf bank_mask:0xf
v_dot2c_f32_bf16_dpp v44, v38, v172 row_newbcast:11 row_mask:0xf bank_mask:0xf
v_dot2c_f32_bf16_dpp v45, v42, v172 row_newbcast:11 row_mask:0xf bank_mask:0xf
v_dot2c_f32_bf16_dpp v46, v38, v173 row_newbcast:11 row_mask:0xf bank_mask:0xf
v_dot2c_f32_bf16_dpp v47, v42, v173 row_newbcast:11 row_mask:0xf bank_mask:0xf
v_dot2c_f32_bf16_dpp v48, v38, v174 row_newbcast:11 row_mask:0xf bank_mask:0xf
v_dot2c_f32_bf16_dpp v49, v42, v174 row_newbcast:11 row_mask:0xf bank_mask:0xf
v_dot2c_f32_bf16_dpp v50, v38, v175 row_newbcast:11 row_mask:0xf bank_mask:0xf
v_dot2c_f32_bf16_dpp v51, v42, v175 row_newbcast:11 row_mask:0xf bank_mask:0xf
s_cmp_lg_u32 s3, 0
s_cbranch_scc1 L_wos_4
v_mov_b32 v13, 308
v_mov_b32 v14, 2
ds_write_b32 v13, v14
L_wos_4:
s_waitcnt vmcnt(12)
v_dot2c_f32_bf16_dpp v44, v38, v176 row_newbcast:12 row_mask:0xf bank_mask:0xf
v_dot2c_f32_bf16_dpp v45, v42, v176 row_newbcast:12 row_mask:0xf bank_mask:0xf
v_dot2c_f32_bf16_dpp v46, v38, v177 row_newbcast:12 row_mask:0xf bank_mask:0xf
v_dot2c_f32_bf16_dpp v47, v42, v177 row_newbcast:12 row_mask:0xf bank_mask:0xf
v_dot2c_f32_bf16_dpp v48, v38, v178 row_newbcast:12 row_mask:0xf bank_mask:0xf
v_dot2c_f32_bf16_dpp v49, v42, v178 row_newbcast:12 row_mask:0xf bank_mask:0xf
v_dot2c_f32_bf16_dpp v50, v38, v179 row_newbcast:12 row_mask:0xf bank_mask:0xf
v_dot2c_f32_bf16_dpp v51, v42, v179 row_newbcast:12 row_mask:0xf bank_mask:0xf
v_dot2c_f32_bf16_dpp v44, v38, v180 row_newbcast:13 row_mask:0xf bank_mask:0xf
v_dot2c_f32_bf16_dpp v45, v42, v180 row_newbcast:13 row_mask:0xf bank_mask:0xf
v_dot2c_f32_bf16_dpp v46, v38, v181 row_newbcast:13 row_mask:0xf bank_mask:0xf
v_dot2c_f32_bf16_dpp v47, v42, v181 row_newbcast:13 row_mask:0xf bank_mask:0xf
v_dot2c_f32_bf16_dpp v48, v38, v182 row_newbcast:13 row_mask:0xf bank_mask:0xf
v_dot2c_f32_bf16_dpp v49, v42, v182 row_newbcast:13 row_mask:0xf bank_mask:0xf
v_dot2c_f32_bf16_dpp v50, v38, v183 row_newbcast:13 row_mask:0xf bank_mask:0xf
v_dot2c_f32_bf16_dpp v51, v42, v183 row_newbcast:13 row_mask:0xf bank_mask:0xf
v_dot2c_f32_bf16_dpp v44, v38, v184 row_newbcast:14 row_mask:0xf bank_mask:0xf
v_dot2c_f32_bf16_dpp v45, v42, v184 row_newbcast:14 row_mask:0xf bank_mask:0xf
v_dot2c_f32_bf16_dpp v46, v38, v185 row_newbcast:14 row_mask:0xf bank_mask:0xf
v_dot2c_f32_bf16_dpp v47, v42, v185 row_newbcast:14 row_mask:0xf bank_mask:0xf
v_dot2c_f32_bf16_dpp v48, v38, v186 row_newbcast:14 row_mask:0xf bank_mask:0xf
v_dot2c_f32_bf16_dpp v49, v42, v186 row_newbcast:14 row_mask:0xf bank_mask:0xf
v_dot2c_f32_bf16_dpp v50, v38, v187 row_newbcast:14 row_mask:0xf bank_mask:0xf
v_dot2c_f32_bf16_dpp v51, v42, v187 row_newbcast:14 row_mask:0xf bank_mask:0xf
v_dot2c_f32_bf16_dpp v44, v38, v188 row_newbcast:15 row_mask:0xf bank_mask:0xf
v_dot2c_f32_bf16_dpp v45, v42, v188 row_newbcast:15 row_mask:0xf bank_mask:0xf
v_dot2c_f32_bf16_dpp v46, v38, v189 row_newbcast:15 row_mask:0xf bank_mask:0xf
v_dot2c_f32_bf16_dpp v47, v42, v189 row_newbcast:15 row_mask:0xf bank_mask:0xf
v_dot2c_f32_bf16_dpp v48, v38, v190 row_newbcast:15 row_mask:0xf bank_mask:0xf
v_dot2c_f32_bf16_dpp v49, v42, v190 row_newbcast:15 row_mask:0xf bank_mask:0xf
v_dot2c_f32_bf16_dpp v50, v38, v191 row_newbcast:15 row_mask:0xf bank_mask:0xf
v_dot2c_f32_bf16_dpp v51, v42, v191 row_newbcast:15 row_mask:0xf bank_mask:0xf
s_waitcnt vmcnt(11)
s_add_u32 s73, s72, 245760
s_and_b32 s73, s73, 0x3ffff
s_add_u32 s73, s73, s71
buffer_load_dwordx4 v[240:243], v1, s[32:35], s73 offen nt
s_waitcnt vmcnt(11)
s_add_u32 s73, s72, 249856
s_and_b32 s73, s73, 0x3ffff
s_add_u32 s73, s73, s71
buffer_load_dwordx4 v[244:247], v1, s[32:35], s73 offen nt
s_waitcnt vmcnt(11)
s_add_u32 s73, s72, 253952
s_and_b32 s73, s73, 0x3ffff
s_add_u32 s73, s73, s71
buffer_load_dwordx4 v[248:251], v1, s[32:35], s73 offen nt
s_waitcnt vmcnt(11)
s_add_u32 s73, s72, 258048
s_and_b32 s73, s73, 0x3ffff
s_add_u32 s73, s73, s71
buffer_load_dwordx4 v[252:255], v1, s[32:35], s73 offen nt
s_waitcnt vmcnt(12)
v_dot2c_f32_bf16_dpp v44, v39, v192 row_newbcast:0 row_mask:0xf bank_mask:0xf
v_dot2c_f32_bf16_dpp v45, v43, v192 row_newbcast:0 row_mask:0xf bank_mask:0xf
v_dot2c_f32_bf16_dpp v46, v39, v193 row_newbcast:0 row_mask:0xf bank_mask:0xf
v_dot2c_f32_bf16_dpp v47, v43, v193 row_newbcast:0 row_mask:0xf bank_mask:0xf
v_dot2c_f32_bf16_dpp v48, v39, v194 row_newbcast:0 row_mask:0xf bank_mask:0xf
v_dot2c_f32_bf16_dpp v49, v43, v194 row_newbcast:0 row_mask:0xf bank_mask:0xf
v_dot2c_f32_bf16_dpp v50, v39, v195 row_newbcast:0 row_mask:0xf bank_mask:0xf
v_dot2c_f32_bf16_dpp v51, v43, v195 row_newbcast:0 row_mask:0xf bank_mask:0xf
v_dot2c_f32_bf16_dpp v44, v39, v196 row_newbcast:1 row_mask:0xf bank_mask:0xf
v_dot2c_f32_bf16_dpp v45, v43, v196 row_newbcast:1 row_mask:0xf bank_mask:0xf
v_dot2c_f32_bf16_dpp v46, v39, v197 row_newbcast:1 row_mask:0xf bank_mask:0xf
v_dot2c_f32_bf16_dpp v47, v43, v197 row_newbcast:1 row_mask:0xf bank_mask:0xf
v_dot2c_f32_bf16_dpp v48, v39, v198 row_newbcast:1 row_mask:0xf bank_mask:0xf
v_dot2c_f32_bf16_dpp v49, v43, v198 row_newbcast:1 row_mask:0xf bank_mask:0xf
v_dot2c_f32_bf16_dpp v50, v39, v199 row_newbcast:1 row_mask:0xf bank_mask:0xf
v_dot2c_f32_bf16_dpp v51, v43, v199 row_newbcast:1 row_mask:0xf bank_mask:0xf
v_dot2c_f32_bf16_dpp v44, v39, v200 row_newbcast:2 row_mask:0xf bank_mask:0xf
v_dot2c_f32_bf16_dpp v45, v43, v200 row_newbcast:2 row_mask:0xf bank_mask:0xf
v_dot2c_f32_bf16_dpp v46, v39, v201 row_newbcast:2 row_mask:0xf bank_mask:0xf
v_dot2c_f32_bf16_dpp v47, v43, v201 row_newbcast:2 row_mask:0xf bank_mask:0xf
v_dot2c_f32_bf16_dpp v48, v39, v202 row_newbcast:2 row_mask:0xf bank_mask:0xf
v_dot2c_f32_bf16_dpp v49, v43, v202 row_newbcast:2 row_mask:0xf bank_mask:0xf
v_dot2c_f32_bf16_dpp v50, v39, v203 row_newbcast:2 row_mask:0xf bank_mask:0xf
v_dot2c_f32_bf16_dpp v51, v43, v203 row_newbcast:2 row_mask:0xf bank_mask:0xf
v_dot2c_f32_bf16_dpp v44, v39, v204 row_newbcast:3 row_mask:0xf bank_mask:0xf
v_dot2c_f32_bf16_dpp v45, v43, v204 row_newbcast:3 row_mask:0xf bank_mask:0xf
v_dot2c_f32_bf16_dpp v46, v39, v205 row_newbcast:3 row_mask:0xf bank_mask:0xf
v_dot2c_f32_bf16_dpp v47, v43, v205 row_newbcast:3 row_mask:0xf bank_mask:0xf
v_dot2c_f32_bf16_dpp v48, v39, v206 row_newbcast:3 row_mask:0xf bank_mask:0xf
v_dot2c_f32_bf16_dpp v49, v43, v206 row_newbcast:3 row_mask:0xf bank_mask:0xf
v_dot2c_f32_bf16_dpp v50, v39, v207 row_newbcast:3 row_mask:0xf bank_mask:0xf
v_dot2c_f32_bf16_dpp v51, v43, v207 row_newbcast:3 row_mask:0xf bank_mask:0xf
s_waitcnt vmcnt(8)
v_dot2c_f32_bf16_dpp v44, v39, v208 row_newbcast:4 row_mask:0xf bank_mask:0xf
v_dot2c_f32_bf16_dpp v45, v43, v208 row_newbcast:4 row_mask:0xf bank_mask:0xf
v_dot2c_f32_bf16_dpp v46, v39, v209 row_newbcast:4 row_mask:0xf bank_mask:0xf
v_dot2c_f32_bf16_dpp v47, v43, v209 row_newbcast:4 row_mask:0xf bank_mask:0xf
v_dot2c_f32_bf16_dpp v48, v39, v210 row_newbcast:4 row_mask:0xf bank_mask:0xf
v_dot2c_f32_bf16_dpp v49, v43, v210 row_newbcast:4 row_mask:0xf bank_mask:0xf
v_dot2c_f32_bf16_dpp v50, v39, v211 row_newbcast:4 row_mask:0xf bank_mask:0xf
v_dot2c_f32_bf16_dpp v51, v43, v211 row_newbcast:4 row_mask:0xf bank_mask:0xf
v_dot2c_f32_bf16_dpp v44, v39, v212 row_newbcast:5 row_mask:0xf bank_mask:0xf
v_dot2c_f32_bf16_dpp v45, v43, v212 row_newbcast:5 row_mask:0xf bank_mask:0xf
v_dot2c_f32_bf16_dpp v46, v39, v213 row_newbcast:5 row_mask:0xf bank_mask:0xf
v_dot2c_f32_bf16_dpp v47, v43, v213 row_newbcast:5 row_mask:0xf bank_mask:0xf
v_dot2c_f32_bf16_dpp v48, v39, v214 row_newbcast:5 row_mask:0xf bank_mask:0xf
v_dot2c_f32_bf16_dpp v49, v43, v214 row_newbcast:5 row_mask:0xf bank_mask:0xf
v_dot2c_f32_bf16_dpp v50, v39, v215 row_newbcast:5 row_mask:0xf bank_mask:0xf
v_dot2c_f32_bf16_dpp v51, v43, v215 row_newbcast:5 row_mask:0xf bank_mask:0xf
v_dot2c_f32_bf16_dpp v44, v39, v216 row_newbcast:6 row_mask:0xf bank_mask:0xf
v_dot2c_f32_bf16_dpp v45, v43, v216 row_newbcast:6 row_mask:0xf bank_mask:0xf
v_dot2c_f32_bf16_dpp v46, v39, v217 row_newbcast:6 row_mask:0xf bank_mask:0xf
v_dot2c_f32_bf16_dpp v47, v43, v217 row_newbcast:6 row_mask:0xf bank_mask:0xf
v_dot2c_f32_bf16_dpp v48, v39, v218 row_newbcast:6 row_mask:0xf bank_mask:0xf
v_dot2c_f32_bf16_dpp v49, v43, v218 row_newbcast:6 row_mask:0xf bank_mask:0xf
v_dot2c_f32_bf16_dpp v50, v39, v219 row_newbcast:6 row_mask:0xf bank_mask:0xf
v_dot2c_f32_bf16_dpp v51, v43, v219 row_newbcast:6 row_mask:0xf bank_mask:0xf
v_dot2c_f32_bf16_dpp v44, v39, v220 row_newbcast:7 row_mask:0xf bank_mask:0xf
v_dot2c_f32_bf16_dpp v45, v43, v220 row_newbcast:7 row_mask:0xf bank_mask:0xf
v_dot2c_f32_bf16_dpp v46, v39, v221 row_newbcast:7 row_mask:0xf bank_mask:0xf
v_dot2c_f32_bf16_dpp v47, v43, v221 row_newbcast:7 row_mask:0xf bank_mask:0xf
v_dot2c_f32_bf16_dpp v48, v39, v222 row_newbcast:7 row_mask:0xf bank_mask:0xf
v_dot2c_f32_bf16_dpp v49, v43, v222 row_newbcast:7 row_mask:0xf bank_mask:0xf
v_dot2c_f32_bf16_dpp v50, v39, v223 row_newbcast:7 row_mask:0xf bank_mask:0xf
v_dot2c_f32_bf16_dpp v51, v43, v223 row_newbcast:7 row_mask:0xf bank_mask:0xf
s_waitcnt vmcnt(4)
v_dot2c_f32_bf16_dpp v44, v39, v224 row_newbcast:8 row_mask:0xf bank_mask:0xf
v_dot2c_f32_bf16_dpp v45, v43, v224 row_newbcast:8 row_mask:0xf bank_mask:0xf
v_dot2c_f32_bf16_dpp v46, v39, v225 row_newbcast:8 row_mask:0xf bank_mask:0xf
v_dot2c_f32_bf16_dpp v47, v43, v225 row_newbcast:8 row_mask:0xf bank_mask:0xf
v_dot2c_f32_bf16_dpp v48, v39, v226 row_newbcast:8 row_mask:0xf bank_mask:0xf
v_dot2c_f32_bf16_dpp v49, v43, v226 row_newbcast:8 row_mask:0xf bank_mask:0xf
v_dot2c_f32_bf16_dpp v50, v39, v227 row_newbcast:8 row_mask:0xf bank_mask:0xf
v_dot2c_f32_bf16_dpp v51, v43, v227 row_newbcast:8 row_mask:0xf bank_mask:0xf
v_dot2c_f32_bf16_dpp v44, v39, v228 row_newbcast:9 row_mask:0xf bank_mask:0xf
v_dot2c_f32_bf16_dpp v45, v43, v228 row_newbcast:9 row_mask:0xf bank_mask:0xf
v_dot2c_f32_bf16_dpp v46, v39, v229 row_newbcast:9 row_mask:0xf bank_mask:0xf
v_dot2c_f32_bf16_dpp v47, v43, v229 row_newbcast:9 row_mask:0xf bank_mask:0xf
v_dot2c_f32_bf16_dpp v48, v39, v230 row_newbcast:9 row_mask:0xf bank_mask:0xf
v_dot2c_f32_bf16_dpp v49, v43, v230 row_newbcast:9 row_mask:0xf bank_mask:0xf
v_dot2c_f32_bf16_dpp v50, v39, v231 row_newbcast:9 row_mask:0xf bank_mask:0xf
v_dot2c_f32_bf16_dpp v51, v43, v231 row_newbcast:9 row_mask:0xf bank_mask:0xf
v_dot2c_f32_bf16_dpp v44, v39, v232 row_newbcast:10 row_mask:0xf bank_mask:0xf
v_dot2c_f32_bf16_dpp v45, v43, v232 row_newbcast:10 row_mask:0xf bank_mask:0xf
v_dot2c_f32_bf16_dpp v46, v39, v233 row_newbcast:10 row_mask:0xf bank_mask:0xf
v_dot2c_f32_bf16_dpp v47, v43, v233 row_newbcast:10 row_mask:0xf bank_mask:0xf
v_dot2c_f32_bf16_dpp v48, v39, v234 row_newbcast:10 row_mask:0xf bank_mask:0xf
v_dot2c_f32_bf16_dpp v49, v43, v234 row_newbcast:10 row_mask:0xf bank_mask:0xf
v_dot2c_f32_bf16_dpp v50, v39, v235 row_newbcast:10 row_mask:0xf bank_mask:0xf
v_dot2c_f32_bf16_dpp v51, v43, v235 row_newbcast:10 row_mask:0xf bank_mask:0xf
v_dot2c_f32_bf16_dpp v44, v39, v236 row_newbcast:11 row_mask:0xf bank_mask:0xf
v_dot2c_f32_bf16_dpp v45, v43, v236 row_newbcast:11 row_mask:0xf bank_mask:0xf
v_dot2c_f32_bf16_dpp v46, v39, v237 row_newbcast:11 row_mask:0xf bank_mask:0xf
v_dot2c_f32_bf16_dpp v47, v43, v237 row_newbcast:11 row_mask:0xf bank_mask:0xf
v_dot2c_f32_bf16_dpp v48, v39, v238 row_newbcast:11 row_mask:0xf bank_mask:0xf
v_dot2c_f32_bf16_dpp v49, v43, v238 row_newbcast:11 row_mask:0xf bank_mask:0xf
v_dot2c_f32_bf16_dpp v50, v39, v239 row_newbcast:11 row_mask:0xf bank_mask:0xf
v_dot2c_f32_bf16_dpp v51, v43, v239 row_newbcast:11 row_mask:0xf bank_mask:0xf
s_waitcnt vmcnt(0)
v_dot2c_f32_bf16_dpp v44, v39, v240 row_newbcast:12 row_mask:0xf bank_mask:0xf
v_dot2c_f32_bf16_dpp v45, v43, v240 row_newbcast:12 row_mask:0xf bank_mask:0xf
v_dot2c_f32_bf16_dpp v46, v39, v241 row_newbcast:12 row_mask:0xf bank_mask:0xf
v_dot2c_f32_bf16_dpp v47, v43, v241 row_newbcast:12 row_mask:0xf bank_mask:0xf
v_dot2c_f32_bf16_dpp v48, v39, v242 row_newbcast:12 row_mask:0xf bank_mask:0xf
v_dot2c_f32_bf16_dpp v49, v43, v242 row_newbcast:12 row_mask:0xf bank_mask:0xf
v_dot2c_f32_bf16_dpp v50, v39, v243 row_newbcast:12 row_mask:0xf bank_mask:0xf
v_dot2c_f32_bf16_dpp v51, v43, v243 row_newbcast:12 row_mask:0xf bank_mask:0xf
v_dot2c_f32_bf16_dpp v44, v39, v244 row_newbcast:13 row_mask:0xf bank_mask:0xf
v_dot2c_f32_bf16_dpp v45, v43, v244 row_newbcast:13 row_mask:0xf bank_mask:0xf
v_dot2c_f32_bf16_dpp v46, v39, v245 row_newbcast:13 row_mask:0xf bank_mask:0xf
v_dot2c_f32_bf16_dpp v47, v43, v245 row_newbcast:13 row_mask:0xf bank_mask:0xf
v_dot2c_f32_bf16_dpp v48, v39, v246 row_newbcast:13 row_mask:0xf bank_mask:0xf
v_dot2c_f32_bf16_dpp v49, v43, v246 row_newbcast:13 row_mask:0xf bank_mask:0xf
v_dot2c_f32_bf16_dpp v50, v39, v247 row_newbcast:13 row_mask:0xf bank_mask:0xf
v_dot2c_f32_bf16_dpp v51, v43, v247 row_newbcast:13 row_mask:0xf bank_mask:0xf
v_dot2c_f32_bf16_dpp v44, v39, v248 row_newbcast:14 row_mask:0xf bank_mask:0xf
v_dot2c_f32_bf16_dpp v45, v43, v248 row_newbcast:14 row_mask:0xf bank_mask:0xf
v_dot2c_f32_bf16_dpp v46, v39, v249 row_newbcast:14 row_mask:0xf bank_mask:0xf
v_dot2c_f32_bf16_dpp v47, v43, v249 row_newbcast:14 row_mask:0xf bank_mask:0xf
v_dot2c_f32_bf16_dpp v48, v39, v250 row_newbcast:14 row_mask:0xf bank_mask:0xf
v_dot2c_f32_bf16_dpp v49, v43, v250 row_newbcast:14 row_mask:0xf bank_mask:0xf
v_dot2c_f32_bf16_dpp v50, v39, v251 row_newbcast:14 row_mask:0xf bank_mask:0xf
v_dot2c_f32_bf16_dpp v51, v43, v251 row_newbcast:14 row_mask:0xf bank_mask:0xf
v_dot2c_f32_bf16_dpp v44, v39, v252 row_newbcast:15 row_mask:0xf bank_mask:0xf
v_dot2c_f32_bf16_dpp v45, v43, v252 row_newbcast:15 row_mask:0xf bank_mask:0xf
v_dot2c_f32_bf16_dpp v46, v39, v253 row_newbcast:15 row_mask:0xf bank_mask:0xf
v_dot2c_f32_bf16_dpp v47, v43, v253 row_newbcast:15 row_mask:0xf bank_mask:0xf
v_dot2c_f32_bf16_dpp v48, v39, v254 row_newbcast:15 row_mask:0xf bank_mask:0xf
v_dot2c_f32_bf16_dpp v49, v43, v254 row_newbcast:15 row_mask:0xf bank_mask:0xf
v_dot2c_f32_bf16_dpp v50, v39, v255 row_newbcast:15 row_mask:0xf bank_mask:0xf
v_dot2c_f32_bf16_dpp v51, v43, v255 row_newbcast:15 row_mask:0xf bank_mask:0xf
v_permlane32_swap_b32 v44, v45
v_permlane32_swap_b32 v46, v47
v_permlane32_swap_b32 v48, v49
v_permlane32_swap_b32 v50, v51
v_add_f32 v44, v44, v45
v_add_f32 v46, v46, v47
v_add_f32 v48, v48, v49
v_add_f32 v50, v50, v51
v_permlane16_swap_b32 v44, v46
s_nop 0
v_permlane16_swap_b32 v48, v50
v_add_f32 v44, v44, v46
v_add_f32 v48, v48, v50
ds_write2_b32 v12, v44, v48 offset0:0 offset1:4
v_mov_b32 v13, 268
v_mov_b32 v14, 1
v_mov_b32 v3, 272
v_lshlrev_b32 v4, 3, v0
s_waitcnt lgkmcnt(0)
s_mov_b64 s[80:81], exec
s_mov_b64 exec, 1
ds_add_rtn_u32 v2, v13, v14
s_mov_b64 exec, s[80:81]
s_lshl_b32 s91, s68, 3
s_add_u32 s91, s91, s82
s_lshl_b32 s91, s91, 11
s_add_u32 s91, s91, 528384
s_waitcnt lgkmcnt(0)
v_readfirstlane_b32 s73, v2
s_nop 0
s_cmp_eq_u32 s73, 3
s_cbranch_scc0 L_notlast
ds_read_b128 v[24:27], v3
ds_read_b128 v[28:31], v3 offset:16
ds_read_b64 v[104:105], v4 offset:4096
ds_read_b64 v[106:107], v4 offset:4608
ds_read_b64 v[108:109], v4 offset:5120
ds_read_b64 v[110:111], v4 offset:5632
v_mov_b32 v18, s26
v_mov_b32 v19, s27
v_mov_b32 v22, s26
v_mov_b32 v23, s27
s_waitcnt lgkmcnt(4)
v_max_f32 v20, v24, v26
v_max3_f32 v20, v20, v28, v30
v_sub_f32 v24, v24, v20
v_sub_f32 v26, v26, v20
v_sub_f32 v28, v28, v20
v_sub_f32 v30, v30, v20
v_mul_f32 v24, 0x3fb8aa3b, v24
v_mul_f32 v26, 0x3fb8aa3b, v26
v_mul_f32 v28, 0x3fb8aa3b, v28
v_mul_f32 v30, 0x3fb8aa3b, v30
v_exp_f32 v24, v24
v_exp_f32 v26, v26
v_exp_f32 v28, v28
v_exp_f32 v30, v30
v_mul_f32 v21, v24, v25
v_fmac_f32 v21, v26, v27
v_fmac_f32 v21, v28, v29
v_fmac_f32 v21, v30, v31
s_waitcnt lgkmcnt(0)
v_mul_f32 v16, v24, v104
v_fmac_f32 v16, v26, v106
v_fmac_f32 v16, v28, v108
v_fmac_f32 v16, v30, v110
v_mul_f32 v17, v24, v105
v_fmac_f32 v17, v26, v107
v_fmac_f32 v17, v28, v109
v_fmac_f32 v17, v30, v111
ds_write_b64 v4, v[16:17] offset:6144
s_mov_b64 s[80:81], exec
s_cmp_eq_u32 s25, 0
s_cbranch_scc1 L_oslow_5
buffer_store_dwordx4 v[16:19], v1, s[56:59], s91 offen
s_mov_b64 exec, 1
buffer_store_dwordx4 v[20:23], v1, s[56:59], s91 offen offset:1024
s_branch L_odone_6
L_oslow_5:
buffer_store_dwordx4 v[16:19], v1, s[56:59], s91 offen sc1
s_mov_b64 exec, 1
buffer_store_dwordx4 v[20:23], v1, s[56:59], s91 offen offset:1024 sc1
L_odone_6:
v_mov_b32 v13, 6656
ds_write_b64 v13, v[20:21]
v_mov_b32 v13, 304
v_mov_b32 v14, 1
s_waitcnt lgkmcnt(0)
ds_write_b32 v13, v14
s_mov_b64 exec, s[80:81]
L_notlast:
v_mov_b32 v13, 316
s_mov_b32 s96, 0
L_rl_7:
ds_read_b32 v12, v13
s_add_u32 s96, s96, 1
s_waitcnt lgkmcnt(0)
v_readfirstlane_b32 s73, v12
s_nop 0
s_cmp_lg_u32 s73, 0
s_cbranch_scc1 L_rl2_8
s_sleep 1
s_cmp_lt_u32 s96, 67108864
s_cbranch_scc1 L_rl_7
L_rl2_8:
s_cmp_le_u32 s73, 4
s_cbranch_scc1 L_xred
s_sub_u32 s73, s73, 5
s_cmp_lt_u32 s73, 3
s_cbranch_scc0 L_done
s_lshr_b32 s74, s68, 3
s_mul_i32 s74, s74, 3
s_add_u32 s73, s73, s74
s_cmp_lt_u32 s73, 11
s_cbranch_scc0 L_done
s_and_b32 s38, s68, 7
s_mul_i32 s38, s38, 11
s_add_u32 s38, s38, s73
s_cmp_lt_u32 s38, 86
s_cbranch_scc0 L_done
v_mov_b32 v12, 256
ds_read_b64 v[8:9], v12
s_waitcnt lgkmcnt(0)
v_readfirstlane_b32 s26, v8
v_readfirstlane_b32 s27, v9
s_mov_b32 s44, s16
s_mov_b32 s45, s17
s_mov_b32 s46, 1409024
s_mov_b32 s47, 0x20000
s_mov_b32 s48, s18
s_mov_b32 s49, s19
s_mov_b32 s50, 1409024
s_mov_b32 s51, 0x20000
s_mul_i32 s92, s3, 32768
s_add_u32 s92, s92, 23296
v_lshrrev_b32 v2, 1, v0
v_mul_u32_u24 v2, 2752, v2
v_and_b32 v13, 1, v0
v_lshl_add_u32 v2, v13, 4, v2
s_lshl_b32 s90, s38, 5
s_mul_i32 s73, s3, 352256
s_add_u32 s90, s90, s73
v_lshrrev_b32 v12, 1, v6
v_add_u32 v13, 0, v7
v_xor_b32 v12, v12, v13
v_lshlrev_b32 v12, 5, v12
v_and_b32 v13, 1, v6
v_lshl_add_u32 v12, v13, 4, v12
v_lshl_add_u32 v3, v7, 10, v12
v_lshrrev_b32 v12, 1, v6
v_add_u32 v13, 4, v7
v_xor_b32 v12, v12, v13
v_lshlrev_b32 v12, 5, v12
v_and_b32 v13, 1, v6
v_lshl_add_u32 v12, v13, 4, v12
v_lshl_add_u32 v4, v7, 10, v12
s_lshl_b32 s91, s38, 14
s_lshl_b32 s73, s3, 8
s_add_u32 s91, s91, s73
v_mov_b32 v13, 304
s_mov_b32 s96, 0
L_fg_9:
ds_read_b32 v12, v13
s_add_u32 s96, s96, 1
s_waitcnt lgkmcnt(0)
v_readfirstlane_b32 s73, v12
s_nop 0
s_cmp_lg_u32 s73, 0
s_cbranch_scc1 L_fg2_10
s_sleep 1
s_cmp_lt_u32 s96, 67108864
s_cbranch_scc1 L_fg_9
L_fg2_10:
s_add_u32 m0, s92, 0
s_add_u32 s73, s90, 0
buffer_load_dwordx4 v2, s[44:47], s73 offen lds
s_add_u32 m0, s92, 1024
s_add_u32 s73, s90, 88064
buffer_load_dwordx4 v2, s[44:47], s73 offen lds
s_add_u32 m0, s92, 2048
s_add_u32 s73, s90, 176128
buffer_load_dwordx4 v2, s[44:47], s73 offen lds
s_add_u32 m0, s92, 3072
s_add_u32 s73, s90, 264192
buffer_load_dwordx4 v2, s[44:47], s73 offen lds
s_add_u32 m0, s92, 4096
s_add_u32 s73, s91, 0
buffer_load_dwordx4 v3, s[48:51], s73 offen lds
s_add_u32 m0, s92, 5120
s_add_u32 s73, s91, 4096
buffer_load_dwordx4 v4, s[48:51], s73 offen lds
s_add_u32 m0, s92, 6144
s_add_u32 s73, s91, 8192
buffer_load_dwordx4 v3, s[48:51], s73 offen lds
s_add_u32 m0, s92, 7168
s_add_u32 s73, s91, 12288
buffer_load_dwordx4 v4, s[48:51], s73 offen lds
v_lshrrev_b32 v12, 2, v6
v_lshl_add_u32 v12, v7, 2, v12
v_and_b32 v13, 3, v0
v_lshlrev_b32 v2, 5, v12
v_lshl_add_u32 v2, v13, 3, v2
v_add_u32 v2, s92, v2
v_and_b32 v14, 7, v12
v_lshlrev_b32 v12, 8, v12
v_lshl_add_u32 v12, v13, 3, v12
s_add_u32 s73, s92, 4096
v_add_u32 v12, s73, v12
v_xor_b32 v13, 0, v14
v_lshl_add_u32 v44, v13, 5, v12
v_xor_b32 v13, 1, v14
v_lshl_add_u32 v45, v13, 5, v12
v_xor_b32 v13, 2, v14
v_lshl_add_u32 v46, v13, 5, v12
v_xor_b32 v13, 3, v14
v_lshl_add_u32 v47, v13, 5, v12
v_xor_b32 v13, 4, v14
v_lshl_add_u32 v48, v13, 5, v12
v_xor_b32 v13, 5, v14
v_lshl_add_u32 v49, v13, 5, v12
v_xor_b32 v13, 6, v14
v_lshl_add_u32 v50, v13, 5, v12
v_xor_b32 v13, 7, v14
v_lshl_add_u32 v51, v13, 5, v12
s_and_b32 s73, s68, 7
s_lshl_b32 s90, s73, 13
s_lshl_b32 s73, s3, 11
s_add_u32 s90, s90, s73
s_add_u32 s90, s90, 2097152
s_lshl_b32 s73, s3, 8
s_add_u32 s73, s73, 1216
v_lshlrev_b32 v52, 1, v0
v_add_u32 v52, s73, v52
v_and_b32 v53, 1, v6
v_mul_u32_u24 v53, 1056, v53
v_lshl_add_u32 v53, v7, 3, v53
v_add_u32 v53, s73, v53
v_mov_b32 v54, 576
v_lshlrev_b32 v55, 2, v0
v_and_b32 v56, 1, v7
v_mul_u32_u24 v56, 48, v56
v_lshl_add_u32 v56, v6, 1, v56
s_mul_i32 s73, s3, 192
s_add_u32 s73, s73, 3328
v_add_u32 v56, s73, v56
v_and_b32 v57, 1, v6
v_mul_u32_u24 v57, 48, v57
v_lshl_add_u32 v57, v7, 3, v57
v_add_u32 v57, s73, v57
v_and_b32 v58, 31, v0
v_lshlrev_b32 v58, 2, v58
s_lshl_b32 s91, s38, 13
s_lshl_b32 s73, s3, 11
s_add_u32 s91, s91, s73
s_add_u32 s91, s91, 1380352
v_mov_b32 v62, s26
v_mov_b32 v63, s27
v_mov_b32 v30, s26
v_mov_b32 v31, s27
s_mov_b32 s92, 0x00010001
s_mov_b32 s93, 0x00010001
s_waitcnt vmcnt(0)
ds_read_b64_tr_b16 v[128:129], v2 offset:0
ds_read_b64_tr_b16 v[130:131], v2 offset:512
ds_read_b64_tr_b16 v[132:133], v2 offset:1024
ds_read_b64_tr_b16 v[134:135], v2 offset:1536
ds_read_b64_tr_b16 v[136:137], v2 offset:2048
ds_read_b64_tr_b16 v[138:139], v2 offset:2560
ds_read_b64_tr_b16 v[140:141], v2 offset:3072
ds_read_b64_tr_b16 v[142:143], v2 offset:3584
ds_read_b64_tr_b16 v[144:145], v44
ds_read_b64_tr_b16 v[146:147], v45
ds_read_b64_tr_b16 v[148:149], v46
ds_read_b64_tr_b16 v[150:151], v47
ds_read_b64_tr_b16 v[152:153], v48
ds_read_b64_tr_b16 v[154:155], v49
ds_read_b64_tr_b16 v[156:157], v50
ds_read_b64_tr_b16 v[158:159], v51
s_mov_b64 s[28:29], -1
s_mov_b64 s[30:31], -1
s_mov_b32 s96, 0
L_poll_11:
s_add_u32 s96, s96, 1
s_mov_b64 exec, s[28:29]
s_cbranch_execz L_sk_13
buffer_load_dwordx4 v[64:67], v1, s[56:59], s90 offen sc1
L_sk_13:
s_mov_b64 exec, s[30:31]
s_cbranch_execz L_sk_14
buffer_load_dwordx4 v[68:71], v1, s[56:59], s90 offen offset:1024 sc1
L_sk_14:
s_mov_b64 exec, -1
s_waitcnt vmcnt(0)
v_cmp_ne_u32 vcc, s26, v66
v_cmp_ne_u32 s[98:99], s27, v67
s_nop 0
s_or_b64 vcc, vcc, s[98:99]
s_and_b64 s[28:29], s[28:29], vcc
s_mov_b64 s[94:95], s[28:29]
v_cmp_ne_u32 vcc, s26, v70
v_cmp_ne_u32 s[98:99], s27, v71
s_nop 0
s_or_b64 vcc, vcc, s[98:99]
s_and_b64 s[30:31], s[30:31], vcc
s_or_b64 s[94:95], s[94:95], s[30:31]
s_cmp_eq_u64 s[94:95], 0
s_cbranch_scc1 L_pok_12
s_cmp_lt_u32 s96, 1048576
s_cbranch_scc1 L_poll_11
L_pok_12:
v_add_f32 v16, v64, v68
v_mul_f32 v18, v64, v64
v_add_f32 v17, v65, v69
v_mul_f32 v19, v65, v65
v_fmac_f32 v18, v68, v68
v_fmac_f32 v19, v69, v69
v_add_f32_dpp v16, v16, v16 row_ror:8 row_mask:0xf bank_mask:0xf
v_add_f32_dpp v17, v17, v17 row_ror:8 row_mask:0xf bank_mask:0xf
v_add_f32_dpp v18, v18, v18 row_ror:8 row_mask:0xf bank_mask:0xf
v_add_f32_dpp v19, v19, v19 row_ror:8 row_mask:0xf bank_mask:0xf
v_add_f32_dpp v16, v16, v16 row_ror:4 row_mask:0xf bank_mask:0xf
v_add_f32_dpp v17, v17, v17 row_ror:4 row_mask:0xf bank_mask:0xf
v_add_f32_dpp v18, v18, v18 row_ror:4 row_mask:0xf bank_mask:0xf
v_add_f32_dpp v19, v19, v19 row_ror:4 row_mask:0xf bank_mask:0xf
v_add_f32_dpp v16, v16, v16 row_ror:2 row_mask:0xf bank_mask:0xf
v_add_f32_dpp v17, v17, v17 row_ror:2 row_mask:0xf bank_mask:0xf
v_add_f32_dpp v18, v18, v18 row_ror:2 row_mask:0xf bank_mask:0xf
v_add_f32_dpp v19, v19, v19 row_ror:2 row_mask:0xf bank_mask:0xf
v_add_f32_dpp v16, v16, v16 row_ror:1 row_mask:0xf bank_mask:0xf
v_add_f32_dpp v17, v17, v17 row_ror:1 row_mask:0xf bank_mask:0xf
v_add_f32_dpp v18, v18, v18 row_ror:1 row_mask:0xf bank_mask:0xf
v_add_f32_dpp v19, v19, v19 row_ror:1 row_mask:0xf bank_mask:0xf
s_mov_b64 exec, s[92:93]
ds_add_f32 v54, v16 offset:0
ds_add_f32 v54, v17 offset:4
ds_add_f32 v54, v18 offset:8
ds_add_f32 v54, v19 offset:12
s_mov_b64 exec, -1
s_waitcnt lgkmcnt(0)
s_barrier
ds_read_b128 v[16:19], v54
s_waitcnt lgkmcnt(0)
v_mul_f32 v16, 0x3b000000, v16
v_mul_f32 v18, 0x3b000000, v18
v_mul_f32 v17, 0x3b000000, v17
v_mul_f32 v19, 0x3b000000, v19
v_fma_f32 v18, -v16, v16, v18
v_fma_f32 v19, -v17, v17, v19
v_max_f32 v18, 0, v18
v_max_f32 v19, 0, v19
v_cvt_pk_bf16_f32 v16, v16, v16
v_cvt_pk_bf16_f32 v17, v17, v17
v_cvt_pk_bf16_f32 v18, v18, v18
v_cvt_pk_bf16_f32 v19, v19, v19
v_and_b32 v16, 0xffff0000, v16
v_and_b32 v17, 0xffff0000, v17
v_and_b32 v18, 0xffff0000, v18
v_and_b32 v19, 0xffff0000, v19
v_add_f32 v18, 0x3727c5ac, v18
v_add_f32 v19, 0x3727c5ac, v19
v_cvt_pk_bf16_f32 v18, v18, v18
v_cvt_pk_bf16_f32 v19, v19, v19
v_and_b32 v18, 0xffff0000, v18
v_and_b32 v19, 0xffff0000, v19
v_sqrt_f32 v18, v18
v_sqrt_f32 v19, v19
v_cvt_pk_bf16_f32 v18, v18, v18
v_cvt_pk_bf16_f32 v19, v19, v19
v_and_b32 v18, 0xffff0000, v18
v_and_b32 v19, 0xffff0000, v19
v_rcp_f32 v18, v18
v_rcp_f32 v19, v19
v_sub_f32 v64, v64, v16
v_sub_f32 v65, v65, v17
v_sub_f32 v68, v68, v16
v_sub_f32 v69, v69, v17
v_cvt_pk_bf16_f32 v64, v64, v64
v_cvt_pk_bf16_f32 v65, v65, v65
v_cvt_pk_bf16_f32 v68, v68, v68
v_cvt_pk_bf16_f32 v69, v69, v69
v_and_b32 v64, 0xffff0000, v64
v_and_b32 v65, 0xffff0000, v65
v_and_b32 v68, 0xffff0000, v68
v_and_b32 v69, 0xffff0000, v69
v_mul_f32 v64, v64, v18
v_mul_f32 v65, v65, v19
v_mul_f32 v68, v68, v18
v_mul_f32 v69, v69, v19
v_cvt_pk_bf16_f32 v64, v64, v65
v_cvt_pk_bf16_f32 v68, v68, v69
ds_write_b16 v52, v64
ds_write_b16_d16_hi v52, v64 offset:1056
ds_write_b16 v52, v68 offset:128
ds_write_b16_d16_hi v52, v68 offset:1184
ds_read2_b64 v[72:75], v53 offset0:0 offset1:4
ds_read2_b64 v[76:79], v53 offset0:8 offset1:12
ds_read2_b64 v[80:83], v53 offset0:16 offset1:20
ds_read2_b64 v[84:87], v53 offset0:24 offset1:28
s_waitcnt lgkmcnt(3)
v_mfma_f32_16x16x32_bf16 v[88:91], v[72:75], v[128:131], 0
s_waitcnt lgkmcnt(2)
v_mfma_f32_16x16x32_bf16 v[88:91], v[76:79], v[132:135], v[88:91]
s_waitcnt lgkmcnt(1)
v_mfma_f32_16x16x32_bf16 v[88:91], v[80:83], v[136:139], v[88:91]
s_waitcnt lgkmcnt(0)
v_mfma_f32_16x16x32_bf16 v[88:91], v[84:87], v[140:143], v[88:91]
s_nop 7
v_cndmask_b32 v16, v88, v89, s[84:85]
s_mov_b32 exec_hi, 0
ds_add_f32 v55, v16 offset:320
s_mov_b32 exec_hi, -1
s_waitcnt lgkmcnt(0)
s_barrier
ds_read_b32 v16, v58 offset:320
s_waitcnt lgkmcnt(0)
v_cvt_pk_bf16_f32 v16, v16, v16
v_and_b32 v16, 0xffff0000, v16
v_mul_f32 v17, 0xbfb8aa3b, v16
v_exp_f32 v17, v17
s_nop 0
v_add_f32 v17, 1.0, v17
v_rcp_f32 v17, v17
s_nop 0
v_mul_f32 v16, v16, v17
v_cvt_pk_bf16_f32 v16, v16, v16
ds_write_b16 v56, v16
ds_read_b64 v[72:73], v57
s_waitcnt lgkmcnt(0)
v_mfma_f32_16x16x16_bf16 v[96:99], v[72:73], v[144:145], 0
v_mfma_f32_16x16x16_bf16 v[100:103], v[72:73], v[146:147], 0
v_mfma_f32_16x16x16_bf16 v[104:107], v[72:73], v[148:149], 0
v_mfma_f32_16x16x16_bf16 v[108:111], v[72:73], v[150:151], 0
v_mfma_f32_16x16x16_bf16 v[112:115], v[72:73], v[152:153], 0
v_mfma_f32_16x16x16_bf16 v[116:119], v[72:73], v[154:155], 0
v_mfma_f32_16x16x16_bf16 v[120:123], v[72:73], v[156:157], 0
v_mfma_f32_16x16x16_bf16 v[124:127], v[72:73], v[158:159], 0
s_nop 1
v_cndmask_b32 v60, v96, v100, s[84:85]
v_cndmask_b32 v60, v60, v104, s[86:87]
v_cndmask_b32 v60, v60, v108, s[88:89]
v_cndmask_b32 v61, v97, v101, s[84:85]
v_cndmask_b32 v61, v61, v105, s[86:87]
v_cndmask_b32 v61, v61, v109, s[88:89]
buffer_store_dwordx4 v[60:63], v1, s[56:59], s91 offen offset:0 sc1
v_cndmask_b32 v28, v112, v116, s[84:85]
v_cndmask_b32 v28, v28, v120, s[86:87]
v_cndmask_b32 v28, v28, v124, s[88:89]
v_cndmask_b32 v29, v113, v117, s[84:85]
v_cndmask_b32 v29, v29, v121, s[86:87]
v_cndmask_b32 v29, v29, v125, s[88:89]
buffer_store_dwordx4 v[28:31], v1, s[56:59], s91 offen offset:1024 sc1
s_branch L_done
L_xred:
s_lshr_b32 s74, s68, 3
s_lshl_b32 s74, s74, 2
s_add_u32 s74, s74, s73
s_sub_u32 s74, s74, 1
s_lshl_b32 s74, s74, 2
s_add_u32 s38, s74, s3
s_mov_b32 s52, s4
s_mov_b32 s53, s5
s_mov_b32 s54, 2048
s_mov_b32 s55, 0x20000
v_and_b32 v12, 7, v0
v_lshlrev_b32 v14, 1, v12
s_lshl_b32 s90, s38, 4
buffer_load_ushort v52, v14, s[52:55], s90 offen
buffer_load_ushort v53, v14, s[52:55], s90 offen offset:1024
v_lshrrev_b32 v2, 3, v0
v_lshlrev_b32 v2, 13, v2
v_lshl_add_u32 v2, v12, 4, v2
s_lshl_b32 s91, s38, 7
s_add_u32 s91, s91, 1052672
s_and_b32 s92, s68, 7
s_lshl_b32 s92, s92, 13
s_lshl_b32 s73, s38, 7
s_add_u32 s92, s92, s73
s_add_u32 s92, s92, 2097152
v_lshlrev_b32 v3, 4, v12
v_mov_b32 v18, s26
v_mov_b32 v19, s27
v_mov_b32 v13, 592
s_mov_b32 s96, 0
L_yd_15:
ds_read_b32 v12, v13
s_add_u32 s96, s96, 1
s_waitcnt lgkmcnt(0)
v_readfirstlane_b32 s73, v12
s_nop 0
s_cmp_lg_u32 s73, 0
s_cbranch_scc1 L_yd2_16
s_sleep 1
s_cmp_lt_u32 s96, 67108864
s_cbranch_scc1 L_yd_15
L_yd2_16:
s_mov_b64 s[28:29], -1
s_mov_b64 s[30:31], -1
s_mov_b64 s[32:33], -1
s_mov_b64 s[34:35], -1
s_mov_b32 s96, 0
L_poll_17:
s_add_u32 s96, s96, 1
s_mov_b64 exec, s[28:29]
s_cbranch_execz L_sk_19
s_add_u32 s73, s91, 0
buffer_load_dwordx4 v[64:67], v2, s[56:59], s73 offen sc1
L_sk_19:
s_mov_b64 exec, s[30:31]
s_cbranch_execz L_sk_20
s_add_u32 s73, s91, 65536
buffer_load_dwordx4 v[68:71], v2, s[56:59], s73 offen sc1
L_sk_20:
s_mov_b64 exec, s[32:33]
s_cbranch_execz L_sk_21
s_add_u32 s73, s91, 131072
buffer_load_dwordx4 v[72:75], v2, s[56:59], s73 offen sc1
L_sk_21:
s_mov_b64 exec, s[34:35]
s_cbranch_execz L_sk_22
s_add_u32 s73, s91, 196608
buffer_load_dwordx4 v[76:79], v2, s[56:59], s73 offen sc1
L_sk_22:
s_mov_b64 exec, -1
s_waitcnt vmcnt(0)
v_cmp_ne_u32 vcc, s26, v66
v_cmp_ne_u32 s[98:99], s27, v67
s_nop 0
s_or_b64 vcc, vcc, s[98:99]
s_and_b64 s[28:29], s[28:29], vcc
s_mov_b64 s[94:95], s[28:29]
v_cmp_ne_u32 vcc, s26, v70
v_cmp_ne_u32 s[98:99], s27, v71
s_nop 0
s_or_b64 vcc, vcc, s[98:99]
s_and_b64 s[30:31], s[30:31], vcc
s_or_b64 s[94:95], s[94:95], s[30:31]
v_cmp_ne_u32 vcc, s26, v74
v_cmp_ne_u32 s[98:99], s27, v75
s_nop 0
s_or_b64 vcc, vcc, s[98:99]
s_and_b64 s[32:33], s[32:33], vcc
s_or_b64 s[94:95], s[94:95], s[32:33]
v_cmp_ne_u32 vcc, s26, v78
v_cmp_ne_u32 s[98:99], s27, v79
s_nop 0
s_or_b64 vcc, vcc, s[98:99]
s_and_b64 s[34:35], s[34:35], vcc
s_or_b64 s[94:95], s[94:95], s[34:35]
s_cmp_eq_u64 s[94:95], 0
s_cbranch_scc1 L_pok_18
s_cmp_lt_u32 s96, 1048576
s_cbranch_scc1 L_poll_17
L_pok_18:
v_add_f32 v64, v64, v68
v_add_f32 v72, v72, v76
v_add_f32 v65, v65, v69
v_add_f32 v73, v73, v77
v_add_f32 v16, v64, v72
v_add_f32 v17, v65, v73
s_nop 0
v_add_f32_dpp v16, v16, v16 row_ror:8 row_mask:0xf bank_mask:0xf
v_add_f32_dpp v17, v17, v17 row_ror:8 row_mask:0xf bank_mask:0xf
v_mov_b32 v20, v16
v_mov_b32 v21, v17
s_nop 0
v_permlane16_swap_b32 v16, v20
v_permlane16_swap_b32 v17, v21
v_add_f32 v16, v16, v20
v_add_f32 v17, v17, v21
v_mov_b32 v20, v16
v_mov_b32 v21, v17
s_nop 0
v_permlane32_swap_b32 v16, v20
v_permlane32_swap_b32 v17, v21
v_add_f32 v16, v16, v20
v_add_f32 v17, v17, v21
v_cvt_pk_bf16_f32 v16, v16, v16
v_lshlrev_b32 v52, 16, v52
v_cvt_pk_bf16_f32 v17, v17, v17
v_lshlrev_b32 v53, 16, v53
v_and_b32 v16, 0xffff0000, v16
v_and_b32 v17, 0xffff0000, v17
v_add_f32 v16, v16, v52
v_add_f32 v17, v17, v53
v_cvt_pk_bf16_f32 v16, v16, v16
v_cvt_pk_bf16_f32 v17, v17, v17
v_and_b32 v16, 0xffff0000, v16
v_and_b32 v17, 0xffff0000, v17
s_mov_b64 exec, 0xff
s_cmp_eq_u32 s25, 0
s_cbranch_scc1 L_hslow_23
buffer_store_dwordx4 v[16:19], v3, s[56:59], s92 offen
s_branch L_hdone_24
L_hslow_23:
buffer_store_dwordx4 v[16:19], v3, s[56:59], s92 offen sc1
L_hdone_24:
s_mov_b64 exec, -1
L_done:
s_endpgm
L_helper:
s_setprio 3
v_mov_b32 v44, 0
v_mov_b32 v45, 0
v_mov_b32 v46, 0
v_mov_b32 v47, 0
v_add_u32 v12, 256, v1
s_mov_b64 s[80:81], exec
s_mov_b64 exec, 0x3fffff
ds_write_b128 v12, v[44:47]
s_mov_b64 exec, s[80:81]
v_lshlrev_b32 v3, 13, v7
v_lshl_add_u32 v3, v6, 4, v3
v_lshl_add_u32 v4, v6, 2, v7
v_lshlrev_b32 v4, 1, v4
s_lshl_b32 s90, s68, 8
s_lshl_b32 s73, s82, 19
s_add_u32 s90, s90, s73
s_lshl_b32 s91, s82, 7
s_waitcnt lgkmcnt(0)
s_mov_b32 s52, s4
s_mov_b32 s53, s5
s_mov_b32 s54, 2048
s_mov_b32 s55, 0x20000
s_mov_b32 s36, s10
s_mov_b32 s37, s11
s_mov_b32 s38, 4194304
s_mov_b32 s39, 0x20000
s_mov_b32 s56, s24
s_mov_b32 s57, s25
s_mov_b32 s58, 268435456
s_mov_b32 s59, 0x20000
buffer_load_dwordx4 v[16:19], v1, s[52:55], 0 offen
buffer_load_dwordx4 v[20:23], v1, s[52:55], 0 offen offset:1024
buffer_load_ushort v52, v4, s[52:55], s91 offen
buffer_load_ushort v53, v4, s[52:55], s91 offen offset:1024
v_mov_b32 v12, 0
buffer_load_dwordx2 v[8:9], v12, s[56:59], 0 offen sc1
s_add_u32 s73, s90, 0
buffer_load_dwordx4 v[64:67], v3, s[36:39], s73 offen
s_add_u32 s73, s90, 32768
buffer_load_dwordx4 v[68:71], v3, s[36:39], s73 offen
s_add_u32 s73, s90, 65536
buffer_load_dwordx4 v[72:75], v3, s[36:39], s73 offen
s_add_u32 s73, s90, 98304
buffer_load_dwordx4 v[76:79], v3, s[36:39], s73 offen
s_add_u32 s73, s90, 131072
buffer_load_dwordx4 v[80:83], v3, s[36:39], s73 offen
s_add_u32 s73, s90, 163840
buffer_load_dwordx4 v[84:87], v3, s[36:39], s73 offen
s_add_u32 s73, s90, 196608
buffer_load_dwordx4 v[88:91], v3, s[36:39], s73 offen
s_add_u32 s73, s90, 229376
buffer_load_dwordx4 v[92:95], v3, s[36:39], s73 offen
s_add_u32 s73, s90, 262144
buffer_load_dwordx4 v[96:99], v3, s[36:39], s73 offen
s_add_u32 s73, s90, 294912
buffer_load_dwordx4 v[100:103], v3, s[36:39], s73 offen
s_add_u32 s73, s90, 327680
buffer_load_dwordx4 v[104:107], v3, s[36:39], s73 offen
s_add_u32 s73, s90, 360448
buffer_load_dwordx4 v[108:111], v3, s[36:39], s73 offen
s_add_u32 s73, s90, 393216
buffer_load_dwordx4 v[112:115], v3, s[36:39], s73 offen
s_add_u32 s73, s90, 425984
buffer_load_dwordx4 v[116:119], v3, s[36:39], s73 offen
s_add_u32 s73, s90, 458752
buffer_load_dwordx4 v[120:123], v3, s[36:39], s73 offen
s_add_u32 s73, s90, 491520
buffer_load_dwordx4 v[124:127], v3, s[36:39], s73 offen
s_barrier
s_mov_b32 s84, 0xffff0000
s_mov_b32 s85, 0
s_mov_b32 s86, 0
s_mov_b32 s87, 0xffff
s_mov_b32 s88, 0
s_mov_b32 s89, 0xffff0000
s_waitcnt vmcnt(16)
v_readfirstlane_b32 s26, v8
v_readfirstlane_b32 s27, v9
s_mul_i32 s26, s26, 1664525
s_add_u32 s26, s26, 1013904223
s_add_u32 s27, s27, 0x9e3779b9
s_getreg_b32 s25, hwreg(HW_REG_XCC_ID)
v_mov_b32 v8, s26
v_mov_b32 v9, s27
v_mov_b32 v12, 256
ds_write_b64 v12, v[8:9]
v_mov_b32 v44, s25
v_mov_b32 v45, 0
v_mov_b32 v46, s26
v_mov_b32 v47, s27
s_lshl_b32 s73, s68, 3
s_add_u32 s73, s73, s82
s_lshl_b32 s73, s73, 11
s_add_u32 s73, s73, 529536
v_mov_b32 v12, 0
s_mov_b64 s[80:81], exec
s_mov_b64 exec, 1
buffer_store_dwordx4 v[44:47], v12, s[56:59], s73 offen sc1
s_mov_b64 exec, s[80:81]
s_lshl_b32 s73, s68, 3
s_add_u32 s73, s73, s82
s_lshl_b32 s73, s73, 11
s_add_u32 s73, s73, 4096
buffer_load_dwordx4 v[168:171], v1, s[56:59], s73 offen
buffer_load_dwordx4 v[172:175], v1, s[56:59], s73 offen offset:1024
s_waitcnt vmcnt(20)
v_lshlrev_b32 v32, 16, v16
v_and_b32 v33, 0xffff0000, v16
v_lshlrev_b32 v34, 16, v17
v_and_b32 v35, 0xffff0000, v17
v_lshlrev_b32 v36, 16, v18
v_and_b32 v37, 0xffff0000, v18
v_lshlrev_b32 v38, 16, v19
v_and_b32 v39, 0xffff0000, v19
v_lshlrev_b32 v40, 16, v20
v_and_b32 v41, 0xffff0000, v20
v_lshlrev_b32 v42, 16, v21
v_and_b32 v43, 0xffff0000, v21
v_lshlrev_b32 v44, 16, v22
v_and_b32 v45, 0xffff0000, v22
v_lshlrev_b32 v46, 16, v23
v_and_b32 v47, 0xffff0000, v23
v_add_f32 v24, v32, v33
v_add_f32 v25, v40, v41
v_add_f32 v24, v24, v34
v_add_f32 v25, v25, v42
v_add_f32 v24, v24, v35
v_add_f32 v25, v25, v43
v_add_f32 v24, v24, v36
v_add_f32 v25, v25, v44
v_add_f32 v24, v24, v37
v_add_f32 v25, v25, v45
v_add_f32 v24, v24, v38
v_add_f32 v25, v25, v46
v_add_f32 v24, v24, v39
v_add_f32 v25, v25, v47
s_nop 0
v_add_f32_dpp v24, v24, v24 row_ror:8 row_mask:0xf bank_mask:0xf
v_add_f32_dpp v25, v25, v25 row_ror:8 row_mask:0xf bank_mask:0xf
s_nop 0
v_add_f32_dpp v24, v24, v24 row_ror:4 row_mask:0xf bank_mask:0xf
v_add_f32_dpp v25, v25, v25 row_ror:4 row_mask:0xf bank_mask:0xf
s_nop 0
v_add_f32_dpp v24, v24, v24 row_ror:2 row_mask:0xf bank_mask:0xf
v_add_f32_dpp v25, v25, v25 row_ror:2 row_mask:0xf bank_mask:0xf
s_nop 0
v_add_f32_dpp v24, v24, v24 row_ror:1 row_mask:0xf bank_mask:0xf
v_add_f32_dpp v25, v25, v25 row_ror:1 row_mask:0xf bank_mask:0xf
v_mov_b32 v28, v24
v_mov_b32 v29, v25
s_nop 0
v_permlane16_swap_b32 v24, v28
v_permlane16_swap_b32 v25, v29
v_add_f32 v24, v24, v28
v_add_f32 v25, v25, v29
v_mov_b32 v28, v24
v_mov_b32 v29, v25
s_nop 0
v_permlane32_swap_b32 v24, v28
v_permlane32_swap_b32 v25, v29
v_add_f32 v24, v24, v28
v_add_f32 v25, v25, v29
v_mul_f32 v24, 0x3b000000, v24
v_mul_f32 v25, 0x3b000000, v25
v_sub_f32 v32, v32, v24
v_sub_f32 v40, v40, v25
v_sub_f32 v33, v33, v24
v_sub_f32 v41, v41, v25
v_sub_f32 v34, v34, v24
v_sub_f32 v42, v42, v25
v_sub_f32 v35, v35, v24
v_sub_f32 v43, v43, v25
v_sub_f32 v36, v36, v24
v_sub_f32 v44, v44, v25
v_sub_f32 v37, v37, v24
v_sub_f32 v45, v45, v25
v_sub_f32 v38, v38, v24
v_sub_f32 v46, v46, v25
v_sub_f32 v39, v39, v24
v_sub_f32 v47, v47, v25
v_mul_f32 v26, v32, v32
v_mul_f32 v27, v40, v40
v_fmac_f32 v26, v33, v33
v_fmac_f32 v27, v41, v41
v_fmac_f32 v26, v34, v34
v_fmac_f32 v27, v42, v42
v_fmac_f32 v26, v35, v35
v_fmac_f32 v27, v43, v43
v_fmac_f32 v26, v36, v36
v_fmac_f32 v27, v44, v44
v_fmac_f32 v26, v37, v37
v_fmac_f32 v27, v45, v45
v_fmac_f32 v26, v38, v38
v_fmac_f32 v27, v46, v46
v_fmac_f32 v26, v39, v39
v_fmac_f32 v27, v47, v47
s_nop 0
v_add_f32_dpp v26, v26, v26 row_ror:8 row_mask:0xf bank_mask:0xf
v_add_f32_dpp v27, v27, v27 row_ror:8 row_mask:0xf bank_mask:0xf
s_nop 0
v_add_f32_dpp v26, v26, v26 row_ror:4 row_mask:0xf bank_mask:0xf
v_add_f32_dpp v27, v27, v27 row_ror:4 row_mask:0xf bank_mask:0xf
s_nop 0
v_add_f32_dpp v26, v26, v26 row_ror:2 row_mask:0xf bank_mask:0xf
v_add_f32_dpp v27, v27, v27 row_ror:2 row_mask:0xf bank_mask:0xf
s_nop 0
v_add_f32_dpp v26, v26, v26 row_ror:1 row_mask:0xf bank_mask:0xf
v_add_f32_dpp v27, v27, v27 row_ror:1 row_mask:0xf bank_mask:0xf
v_mov_b32 v28, v26
v_mov_b32 v29, v27
s_nop 0
v_permlane16_swap_b32 v26, v28
v_permlane16_swap_b32 v27, v29
v_add_f32 v26, v26, v28
v_add_f32 v27, v27, v29
v_mov_b32 v28, v26
v_mov_b32 v29, v27
s_nop 0
v_permlane32_swap_b32 v26, v28
v_permlane32_swap_b32 v27, v29
v_add_f32 v26, v26, v28
v_add_f32 v27, v27, v29
v_mul_f32 v26, 0x3b000000, v26
v_mul_f32 v27, 0x3b000000, v27
v_cvt_pk_bf16_f32 v24, v24, v24
v_and_b32 v24, 0xffff0000, v24
v_cvt_pk_bf16_f32 v26, v26, v26
v_and_b32 v26, 0xffff0000, v26
v_add_f32 v26, 0x3727c5ac, v26
v_cvt_pk_bf16_f32 v26, v26, v26
v_and_b32 v26, 0xffff0000, v26
v_sqrt_f32 v26, v26
s_nop 0
v_cvt_pk_bf16_f32 v26, v26, v26
v_and_b32 v26, 0xffff0000, v26
v_rcp_f32 v26, v26
v_cvt_pk_bf16_f32 v25, v25, v25
v_and_b32 v25, 0xffff0000, v25
v_cvt_pk_bf16_f32 v27, v27, v27
v_and_b32 v27, 0xffff0000, v27
v_add_f32 v27, 0x3727c5ac, v27
v_cvt_pk_bf16_f32 v27, v27, v27
v_and_b32 v27, 0xffff0000, v27
v_sqrt_f32 v27, v27
s_nop 0
v_cvt_pk_bf16_f32 v27, v27, v27
v_and_b32 v27, 0xffff0000, v27
v_rcp_f32 v27, v27
v_lshlrev_b32 v52, 16, v52
v_sub_f32 v52, v52, v24
v_cvt_pk_bf16_f32 v52, v52, v52
v_and_b32 v52, 0xffff0000, v52
v_mul_f32 v52, v52, v26
v_cvt_pk_bf16_f32 v54, 0, v52
v_cvt_pk_bf16_f32 v52, v52, 0
v_lshlrev_b32 v53, 16, v53
v_sub_f32 v53, v53, v25
v_cvt_pk_bf16_f32 v53, v53, v53
v_and_b32 v53, 0xffff0000, v53
v_mul_f32 v53, v53, v27
v_cvt_pk_bf16_f32 v55, 0, v53
v_cvt_pk_bf16_f32 v53, v53, 0
v_and_b32 v12, 7, v0
v_lshlrev_b32 v14, 11, v12
v_bfe_u32 v12, v0, 3, 2
v_lshlrev_b32 v12, 17, v12
v_add_u32 v14, v14, v12
s_and_b32 s93, s68, 7
s_lshl_b32 s93, s93, 14
s_add_u32 s93, s93, 529536
v_mov_b32 v32, 0
v_mov_b32 v33, 0
v_mov_b32 v34, 0
v_mov_b32 v35, 0
v_mov_b32 v36, 0
v_mov_b32 v37, 0
v_mov_b32 v38, 0
v_mov_b32 v39, 0
v_mov_b32 v40, 0
v_mov_b32 v41, 0
v_mov_b32 v42, 0
v_mov_b32 v43, 0
v_mov_b32 v44, 0
v_mov_b32 v45, 0
v_mov_b32 v46, 0
v_mov_b32 v47, 0
s_waitcnt vmcnt(15)
v_dot2c_f32_bf16_dpp v32, v52, v64 row_newbcast:0 row_mask:0xf bank_mask:0xf
v_dot2c_f32_bf16_dpp v33, v54, v64 row_newbcast:0 row_mask:0xf bank_mask:0xf
v_dot2c_f32_bf16_dpp v34, v52, v65 row_newbcast:0 row_mask:0xf bank_mask:0xf
v_dot2c_f32_bf16_dpp v35, v54, v65 row_newbcast:0 row_mask:0xf bank_mask:0xf
v_dot2c_f32_bf16_dpp v36, v52, v66 row_newbcast:0 row_mask:0xf bank_mask:0xf
v_dot2c_f32_bf16_dpp v37, v54, v66 row_newbcast:0 row_mask:0xf bank_mask:0xf
v_dot2c_f32_bf16_dpp v38, v52, v67 row_newbcast:0 row_mask:0xf bank_mask:0xf
v_dot2c_f32_bf16_dpp v39, v54, v67 row_newbcast:0 row_mask:0xf bank_mask:0xf
v_dot2c_f32_bf16_dpp v40, v53, v64 row_newbcast:0 row_mask:0xf bank_mask:0xf
v_dot2c_f32_bf16_dpp v41, v55, v64 row_newbcast:0 row_mask:0xf bank_mask:0xf
v_dot2c_f32_bf16_dpp v42, v53, v65 row_newbcast:0 row_mask:0xf bank_mask:0xf
v_dot2c_f32_bf16_dpp v43, v55, v65 row_newbcast:0 row_mask:0xf bank_mask:0xf
v_dot2c_f32_bf16_dpp v44, v53, v66 row_newbcast:0 row_mask:0xf bank_mask:0xf
v_dot2c_f32_bf16_dpp v45, v55, v66 row_newbcast:0 row_mask:0xf bank_mask:0xf
v_dot2c_f32_bf16_dpp v46, v53, v67 row_newbcast:0 row_mask:0xf bank_mask:0xf
v_dot2c_f32_bf16_dpp v47, v55, v67 row_newbcast:0 row_mask:0xf bank_mask:0xf
v_dot2c_f32_bf16_dpp v32, v52, v68 row_newbcast:1 row_mask:0xf bank_mask:0xf
v_dot2c_f32_bf16_dpp v33, v54, v68 row_newbcast:1 row_mask:0xf bank_mask:0xf
v_dot2c_f32_bf16_dpp v34, v52, v69 row_newbcast:1 row_mask:0xf bank_mask:0xf
v_dot2c_f32_bf16_dpp v35, v54, v69 row_newbcast:1 row_mask:0xf bank_mask:0xf
v_dot2c_f32_bf16_dpp v36, v52, v70 row_newbcast:1 row_mask:0xf bank_mask:0xf
v_dot2c_f32_bf16_dpp v37, v54, v70 row_newbcast:1 row_mask:0xf bank_mask:0xf
v_dot2c_f32_bf16_dpp v38, v52, v71 row_newbcast:1 row_mask:0xf bank_mask:0xf
v_dot2c_f32_bf16_dpp v39, v54, v71 row_newbcast:1 row_mask:0xf bank_mask:0xf
v_dot2c_f32_bf16_dpp v40, v53, v68 row_newbcast:1 row_mask:0xf bank_mask:0xf
v_dot2c_f32_bf16_dpp v41, v55, v68 row_newbcast:1 row_mask:0xf bank_mask:0xf
v_dot2c_f32_bf16_dpp v42, v53, v69 row_newbcast:1 row_mask:0xf bank_mask:0xf
v_dot2c_f32_bf16_dpp v43, v55, v69 row_newbcast:1 row_mask:0xf bank_mask:0xf
v_dot2c_f32_bf16_dpp v44, v53, v70 row_newbcast:1 row_mask:0xf bank_mask:0xf
v_dot2c_f32_bf16_dpp v45, v55, v70 row_newbcast:1 row_mask:0xf bank_mask:0xf
v_dot2c_f32_bf16_dpp v46, v53, v71 row_newbcast:1 row_mask:0xf bank_mask:0xf
v_dot2c_f32_bf16_dpp v47, v55, v71 row_newbcast:1 row_mask:0xf bank_mask:0xf
v_dot2c_f32_bf16_dpp v32, v52, v72 row_newbcast:2 row_mask:0xf bank_mask:0xf
v_dot2c_f32_bf16_dpp v33, v54, v72 row_newbcast:2 row_mask:0xf bank_mask:0xf
v_dot2c_f32_bf16_dpp v34, v52, v73 row_newbcast:2 row_mask:0xf bank_mask:0xf
v_dot2c_f32_bf16_dpp v35, v54, v73 row_newbcast:2 row_mask:0xf bank_mask:0xf
v_dot2c_f32_bf16_dpp v36, v52, v74 row_newbcast:2 row_mask:0xf bank_mask:0xf
v_dot2c_f32_bf16_dpp v37, v54, v74 row_newbcast:2 row_mask:0xf bank_mask:0xf
v_dot2c_f32_bf16_dpp v38, v52, v75 row_newbcast:2 row_mask:0xf bank_mask:0xf
v_dot2c_f32_bf16_dpp v39, v54, v75 row_newbcast:2 row_mask:0xf bank_mask:0xf
v_dot2c_f32_bf16_dpp v40, v53, v72 row_newbcast:2 row_mask:0xf bank_mask:0xf
v_dot2c_f32_bf16_dpp v41, v55, v72 row_newbcast:2 row_mask:0xf bank_mask:0xf
v_dot2c_f32_bf16_dpp v42, v53, v73 row_newbcast:2 row_mask:0xf bank_mask:0xf
v_dot2c_f32_bf16_dpp v43, v55, v73 row_newbcast:2 row_mask:0xf bank_mask:0xf
v_dot2c_f32_bf16_dpp v44, v53, v74 row_newbcast:2 row_mask:0xf bank_mask:0xf
v_dot2c_f32_bf16_dpp v45, v55, v74 row_newbcast:2 row_mask:0xf bank_mask:0xf
v_dot2c_f32_bf16_dpp v46, v53, v75 row_newbcast:2 row_mask:0xf bank_mask:0xf
v_dot2c_f32_bf16_dpp v47, v55, v75 row_newbcast:2 row_mask:0xf bank_mask:0xf
v_dot2c_f32_bf16_dpp v32, v52, v76 row_newbcast:3 row_mask:0xf bank_mask:0xf
v_dot2c_f32_bf16_dpp v33, v54, v76 row_newbcast:3 row_mask:0xf bank_mask:0xf
v_dot2c_f32_bf16_dpp v34, v52, v77 row_newbcast:3 row_mask:0xf bank_mask:0xf
v_dot2c_f32_bf16_dpp v35, v54, v77 row_newbcast:3 row_mask:0xf bank_mask:0xf
v_dot2c_f32_bf16_dpp v36, v52, v78 row_newbcast:3 row_mask:0xf bank_mask:0xf
v_dot2c_f32_bf16_dpp v37, v54, v78 row_newbcast:3 row_mask:0xf bank_mask:0xf
v_dot2c_f32_bf16_dpp v38, v52, v79 row_newbcast:3 row_mask:0xf bank_mask:0xf
v_dot2c_f32_bf16_dpp v39, v54, v79 row_newbcast:3 row_mask:0xf bank_mask:0xf
v_dot2c_f32_bf16_dpp v40, v53, v76 row_newbcast:3 row_mask:0xf bank_mask:0xf
v_dot2c_f32_bf16_dpp v41, v55, v76 row_newbcast:3 row_mask:0xf bank_mask:0xf
v_dot2c_f32_bf16_dpp v42, v53, v77 row_newbcast:3 row_mask:0xf bank_mask:0xf
v_dot2c_f32_bf16_dpp v43, v55, v77 row_newbcast:3 row_mask:0xf bank_mask:0xf
v_dot2c_f32_bf16_dpp v44, v53, v78 row_newbcast:3 row_mask:0xf bank_mask:0xf
v_dot2c_f32_bf16_dpp v45, v55, v78 row_newbcast:3 row_mask:0xf bank_mask:0xf
v_dot2c_f32_bf16_dpp v46, v53, v79 row_newbcast:3 row_mask:0xf bank_mask:0xf
v_dot2c_f32_bf16_dpp v47, v55, v79 row_newbcast:3 row_mask:0xf bank_mask:0xf
s_waitcnt vmcnt(11)
v_dot2c_f32_bf16_dpp v32, v52, v80 row_newbcast:4 row_mask:0xf bank_mask:0xf
v_dot2c_f32_bf16_dpp v33, v54, v80 row_newbcast:4 row_mask:0xf bank_mask:0xf
v_dot2c_f32_bf16_dpp v34, v52, v81 row_newbcast:4 row_mask:0xf bank_mask:0xf
v_dot2c_f32_bf16_dpp v35, v54, v81 row_newbcast:4 row_mask:0xf bank_mask:0xf
v_dot2c_f32_bf16_dpp v36, v52, v82 row_newbcast:4 row_mask:0xf bank_mask:0xf
v_dot2c_f32_bf16_dpp v37, v54, v82 row_newbcast:4 row_mask:0xf bank_mask:0xf
v_dot2c_f32_bf16_dpp v38, v52, v83 row_newbcast:4 row_mask:0xf bank_mask:0xf
v_dot2c_f32_bf16_dpp v39, v54, v83 row_newbcast:4 row_mask:0xf bank_mask:0xf
v_dot2c_f32_bf16_dpp v40, v53, v80 row_newbcast:4 row_mask:0xf bank_mask:0xf
v_dot2c_f32_bf16_dpp v41, v55, v80 row_newbcast:4 row_mask:0xf bank_mask:0xf
v_dot2c_f32_bf16_dpp v42, v53, v81 row_newbcast:4 row_mask:0xf bank_mask:0xf
v_dot2c_f32_bf16_dpp v43, v55, v81 row_newbcast:4 row_mask:0xf bank_mask:0xf
v_dot2c_f32_bf16_dpp v44, v53, v82 row_newbcast:4 row_mask:0xf bank_mask:0xf
v_dot2c_f32_bf16_dpp v45, v55, v82 row_newbcast:4 row_mask:0xf bank_mask:0xf
v_dot2c_f32_bf16_dpp v46, v53, v83 row_newbcast:4 row_mask:0xf bank_mask:0xf
v_dot2c_f32_bf16_dpp v47, v55, v83 row_newbcast:4 row_mask:0xf bank_mask:0xf
v_dot2c_f32_bf16_dpp v32, v52, v84 row_newbcast:5 row_mask:0xf bank_mask:0xf
v_dot2c_f32_bf16_dpp v33, v54, v84 row_newbcast:5 row_mask:0xf bank_mask:0xf
v_dot2c_f32_bf16_dpp v34, v52, v85 row_newbcast:5 row_mask:0xf bank_mask:0xf
v_dot2c_f32_bf16_dpp v35, v54, v85 row_newbcast:5 row_mask:0xf bank_mask:0xf
v_dot2c_f32_bf16_dpp v36, v52, v86 row_newbcast:5 row_mask:0xf bank_mask:0xf
v_dot2c_f32_bf16_dpp v37, v54, v86 row_newbcast:5 row_mask:0xf bank_mask:0xf
v_dot2c_f32_bf16_dpp v38, v52, v87 row_newbcast:5 row_mask:0xf bank_mask:0xf
v_dot2c_f32_bf16_dpp v39, v54, v87 row_newbcast:5 row_mask:0xf bank_mask:0xf
v_dot2c_f32_bf16_dpp v40, v53, v84 row_newbcast:5 row_mask:0xf bank_mask:0xf
v_dot2c_f32_bf16_dpp v41, v55, v84 row_newbcast:5 row_mask:0xf bank_mask:0xf
v_dot2c_f32_bf16_dpp v42, v53, v85 row_newbcast:5 row_mask:0xf bank_mask:0xf
v_dot2c_f32_bf16_dpp v43, v55, v85 row_newbcast:5 row_mask:0xf bank_mask:0xf
v_dot2c_f32_bf16_dpp v44, v53, v86 row_newbcast:5 row_mask:0xf bank_mask:0xf
v_dot2c_f32_bf16_dpp v45, v55, v86 row_newbcast:5 row_mask:0xf bank_mask:0xf
v_dot2c_f32_bf16_dpp v46, v53, v87 row_newbcast:5 row_mask:0xf bank_mask:0xf
v_dot2c_f32_bf16_dpp v47, v55, v87 row_newbcast:5 row_mask:0xf bank_mask:0xf
v_dot2c_f32_bf16_dpp v32, v52, v88 row_newbcast:6 row_mask:0xf bank_mask:0xf
v_dot2c_f32_bf16_dpp v33, v54, v88 row_newbcast:6 row_mask:0xf bank_mask:0xf
v_dot2c_f32_bf16_dpp v34, v52, v89 row_newbcast:6 row_mask:0xf bank_mask:0xf
v_dot2c_f32_bf16_dpp v35, v54, v89 row_newbcast:6 row_mask:0xf bank_mask:0xf
v_dot2c_f32_bf16_dpp v36, v52, v90 row_newbcast:6 row_mask:0xf bank_mask:0xf
v_dot2c_f32_bf16_dpp v37, v54, v90 row_newbcast:6 row_mask:0xf bank_mask:0xf
v_dot2c_f32_bf16_dpp v38, v52, v91 row_newbcast:6 row_mask:0xf bank_mask:0xf
v_dot2c_f32_bf16_dpp v39, v54, v91 row_newbcast:6 row_mask:0xf bank_mask:0xf
v_dot2c_f32_bf16_dpp v40, v53, v88 row_newbcast:6 row_mask:0xf bank_mask:0xf
v_dot2c_f32_bf16_dpp v41, v55, v88 row_newbcast:6 row_mask:0xf bank_mask:0xf
v_dot2c_f32_bf16_dpp v42, v53, v89 row_newbcast:6 row_mask:0xf bank_mask:0xf
v_dot2c_f32_bf16_dpp v43, v55, v89 row_newbcast:6 row_mask:0xf bank_mask:0xf
v_dot2c_f32_bf16_dpp v44, v53, v90 row_newbcast:6 row_mask:0xf bank_mask:0xf
v_dot2c_f32_bf16_dpp v45, v55, v90 row_newbcast:6 row_mask:0xf bank_mask:0xf
v_dot2c_f32_bf16_dpp v46, v53, v91 row_newbcast:6 row_mask:0xf bank_mask:0xf
v_dot2c_f32_bf16_dpp v47, v55, v91 row_newbcast:6 row_mask:0xf bank_mask:0xf
v_dot2c_f32_bf16_dpp v32, v52, v92 row_newbcast:7 row_mask:0xf bank_mask:0xf
v_dot2c_f32_bf16_dpp v33, v54, v92 row_newbcast:7 row_mask:0xf bank_mask:0xf
v_dot2c_f32_bf16_dpp v34, v52, v93 row_newbcast:7 row_mask:0xf bank_mask:0xf
v_dot2c_f32_bf16_dpp v35, v54, v93 row_newbcast:7 row_mask:0xf bank_mask:0xf
v_dot2c_f32_bf16_dpp v36, v52, v94 row_newbcast:7 row_mask:0xf bank_mask:0xf
v_dot2c_f32_bf16_dpp v37, v54, v94 row_newbcast:7 row_mask:0xf bank_mask:0xf
v_dot2c_f32_bf16_dpp v38, v52, v95 row_newbcast:7 row_mask:0xf bank_mask:0xf
v_dot2c_f32_bf16_dpp v39, v54, v95 row_newbcast:7 row_mask:0xf bank_mask:0xf
v_dot2c_f32_bf16_dpp v40, v53, v92 row_newbcast:7 row_mask:0xf bank_mask:0xf
v_dot2c_f32_bf16_dpp v41, v55, v92 row_newbcast:7 row_mask:0xf bank_mask:0xf
v_dot2c_f32_bf16_dpp v42, v53, v93 row_newbcast:7 row_mask:0xf bank_mask:0xf
v_dot2c_f32_bf16_dpp v43, v55, v93 row_newbcast:7 row_mask:0xf bank_mask:0xf
v_dot2c_f32_bf16_dpp v44, v53, v94 row_newbcast:7 row_mask:0xf bank_mask:0xf
v_dot2c_f32_bf16_dpp v45, v55, v94 row_newbcast:7 row_mask:0xf bank_mask:0xf
v_dot2c_f32_bf16_dpp v46, v53, v95 row_newbcast:7 row_mask:0xf bank_mask:0xf
v_dot2c_f32_bf16_dpp v47, v55, v95 row_newbcast:7 row_mask:0xf bank_mask:0xf
s_waitcnt vmcnt(7)
v_dot2c_f32_bf16_dpp v32, v52, v96 row_newbcast:8 row_mask:0xf bank_mask:0xf
v_dot2c_f32_bf16_dpp v33, v54, v96 row_newbcast:8 row_mask:0xf bank_mask:0xf
v_dot2c_f32_bf16_dpp v34, v52, v97 row_newbcast:8 row_mask:0xf bank_mask:0xf
v_dot2c_f32_bf16_dpp v35, v54, v97 row_newbcast:8 row_mask:0xf bank_mask:0xf
v_dot2c_f32_bf16_dpp v36, v52, v98 row_newbcast:8 row_mask:0xf bank_mask:0xf
v_dot2c_f32_bf16_dpp v37, v54, v98 row_newbcast:8 row_mask:0xf bank_mask:0xf
v_dot2c_f32_bf16_dpp v38, v52, v99 row_newbcast:8 row_mask:0xf bank_mask:0xf
v_dot2c_f32_bf16_dpp v39, v54, v99 row_newbcast:8 row_mask:0xf bank_mask:0xf
v_dot2c_f32_bf16_dpp v40, v53, v96 row_newbcast:8 row_mask:0xf bank_mask:0xf
v_dot2c_f32_bf16_dpp v41, v55, v96 row_newbcast:8 row_mask:0xf bank_mask:0xf
v_dot2c_f32_bf16_dpp v42, v53, v97 row_newbcast:8 row_mask:0xf bank_mask:0xf
v_dot2c_f32_bf16_dpp v43, v55, v97 row_newbcast:8 row_mask:0xf bank_mask:0xf
v_dot2c_f32_bf16_dpp v44, v53, v98 row_newbcast:8 row_mask:0xf bank_mask:0xf
v_dot2c_f32_bf16_dpp v45, v55, v98 row_newbcast:8 row_mask:0xf bank_mask:0xf
v_dot2c_f32_bf16_dpp v46, v53, v99 row_newbcast:8 row_mask:0xf bank_mask:0xf
v_dot2c_f32_bf16_dpp v47, v55, v99 row_newbcast:8 row_mask:0xf bank_mask:0xf
v_dot2c_f32_bf16_dpp v32, v52, v100 row_newbcast:9 row_mask:0xf bank_mask:0xf
v_dot2c_f32_bf16_dpp v33, v54, v100 row_newbcast:9 row_mask:0xf bank_mask:0xf
v_dot2c_f32_bf16_dpp v34, v52, v101 row_newbcast:9 row_mask:0xf bank_mask:0xf
v_dot2c_f32_bf16_dpp v35, v54, v101 row_newbcast:9 row_mask:0xf bank_mask:0xf
v_dot2c_f32_bf16_dpp v36, v52, v102 row_newbcast:9 row_mask:0xf bank_mask:0xf
v_dot2c_f32_bf16_dpp v37, v54, v102 row_newbcast:9 row_mask:0xf bank_mask:0xf
v_dot2c_f32_bf16_dpp v38, v52, v103 row_newbcast:9 row_mask:0xf bank_mask:0xf
v_dot2c_f32_bf16_dpp v39, v54, v103 row_newbcast:9 row_mask:0xf bank_mask:0xf
v_dot2c_f32_bf16_dpp v40, v53, v100 row_newbcast:9 row_mask:0xf bank_mask:0xf
v_dot2c_f32_bf16_dpp v41, v55, v100 row_newbcast:9 row_mask:0xf bank_mask:0xf
v_dot2c_f32_bf16_dpp v42, v53, v101 row_newbcast:9 row_mask:0xf bank_mask:0xf
v_dot2c_f32_bf16_dpp v43, v55, v101 row_newbcast:9 row_mask:0xf bank_mask:0xf
v_dot2c_f32_bf16_dpp v44, v53, v102 row_newbcast:9 row_mask:0xf bank_mask:0xf
v_dot2c_f32_bf16_dpp v45, v55, v102 row_newbcast:9 row_mask:0xf bank_mask:0xf
v_dot2c_f32_bf16_dpp v46, v53, v103 row_newbcast:9 row_mask:0xf bank_mask:0xf
v_dot2c_f32_bf16_dpp v47, v55, v103 row_newbcast:9 row_mask:0xf bank_mask:0xf
v_dot2c_f32_bf16_dpp v32, v52, v104 row_newbcast:10 row_mask:0xf bank_mask:0xf
v_dot2c_f32_bf16_dpp v33, v54, v104 row_newbcast:10 row_mask:0xf bank_mask:0xf
v_dot2c_f32_bf16_dpp v34, v52, v105 row_newbcast:10 row_mask:0xf bank_mask:0xf
v_dot2c_f32_bf16_dpp v35, v54, v105 row_newbcast:10 row_mask:0xf bank_mask:0xf
v_dot2c_f32_bf16_dpp v36, v52, v106 row_newbcast:10 row_mask:0xf bank_mask:0xf
v_dot2c_f32_bf16_dpp v37, v54, v106 row_newbcast:10 row_mask:0xf bank_mask:0xf
v_dot2c_f32_bf16_dpp v38, v52, v107 row_newbcast:10 row_mask:0xf bank_mask:0xf
v_dot2c_f32_bf16_dpp v39, v54, v107 row_newbcast:10 row_mask:0xf bank_mask:0xf
v_dot2c_f32_bf16_dpp v40, v53, v104 row_newbcast:10 row_mask:0xf bank_mask:0xf
v_dot2c_f32_bf16_dpp v41, v55, v104 row_newbcast:10 row_mask:0xf bank_mask:0xf
v_dot2c_f32_bf16_dpp v42, v53, v105 row_newbcast:10 row_mask:0xf bank_mask:0xf
v_dot2c_f32_bf16_dpp v43, v55, v105 row_newbcast:10 row_mask:0xf bank_mask:0xf
v_dot2c_f32_bf16_dpp v44, v53, v106 row_newbcast:10 row_mask:0xf bank_mask:0xf
v_dot2c_f32_bf16_dpp v45, v55, v106 row_newbcast:10 row_mask:0xf bank_mask:0xf
v_dot2c_f32_bf16_dpp v46, v53, v107 row_newbcast:10 row_mask:0xf bank_mask:0xf
v_dot2c_f32_bf16_dpp v47, v55, v107 row_newbcast:10 row_mask:0xf bank_mask:0xf
v_dot2c_f32_bf16_dpp v32, v52, v108 row_newbcast:11 row_mask:0xf bank_mask:0xf
v_dot2c_f32_bf16_dpp v33, v54, v108 row_newbcast:11 row_mask:0xf bank_mask:0xf
v_dot2c_f32_bf16_dpp v34, v52, v109 row_newbcast:11 row_mask:0xf bank_mask:0xf
v_dot2c_f32_bf16_dpp v35, v54, v109 row_newbcast:11 row_mask:0xf bank_mask:0xf
v_dot2c_f32_bf16_dpp v36, v52, v110 row_newbcast:11 row_mask:0xf bank_mask:0xf
v_dot2c_f32_bf16_dpp v37, v54, v110 row_newbcast:11 row_mask:0xf bank_mask:0xf
v_dot2c_f32_bf16_dpp v38, v52, v111 row_newbcast:11 row_mask:0xf bank_mask:0xf
v_dot2c_f32_bf16_dpp v39, v54, v111 row_newbcast:11 row_mask:0xf bank_mask:0xf
v_dot2c_f32_bf16_dpp v40, v53, v108 row_newbcast:11 row_mask:0xf bank_mask:0xf
v_dot2c_f32_bf16_dpp v41, v55, v108 row_newbcast:11 row_mask:0xf bank_mask:0xf
v_dot2c_f32_bf16_dpp v42, v53, v109 row_newbcast:11 row_mask:0xf bank_mask:0xf
v_dot2c_f32_bf16_dpp v43, v55, v109 row_newbcast:11 row_mask:0xf bank_mask:0xf
v_dot2c_f32_bf16_dpp v44, v53, v110 row_newbcast:11 row_mask:0xf bank_mask:0xf
v_dot2c_f32_bf16_dpp v45, v55, v110 row_newbcast:11 row_mask:0xf bank_mask:0xf
v_dot2c_f32_bf16_dpp v46, v53, v111 row_newbcast:11 row_mask:0xf bank_mask:0xf
v_dot2c_f32_bf16_dpp v47, v55, v111 row_newbcast:11 row_mask:0xf bank_mask:0xf
s_waitcnt vmcnt(3)
v_dot2c_f32_bf16_dpp v32, v52, v112 row_newbcast:12 row_mask:0xf bank_mask:0xf
v_dot2c_f32_bf16_dpp v33, v54, v112 row_newbcast:12 row_mask:0xf bank_mask:0xf
v_dot2c_f32_bf16_dpp v34, v52, v113 row_newbcast:12 row_mask:0xf bank_mask:0xf
v_dot2c_f32_bf16_dpp v35, v54, v113 row_newbcast:12 row_mask:0xf bank_mask:0xf
v_dot2c_f32_bf16_dpp v36, v52, v114 row_newbcast:12 row_mask:0xf bank_mask:0xf
v_dot2c_f32_bf16_dpp v37, v54, v114 row_newbcast:12 row_mask:0xf bank_mask:0xf
v_dot2c_f32_bf16_dpp v38, v52, v115 row_newbcast:12 row_mask:0xf bank_mask:0xf
v_dot2c_f32_bf16_dpp v39, v54, v115 row_newbcast:12 row_mask:0xf bank_mask:0xf
v_dot2c_f32_bf16_dpp v40, v53, v112 row_newbcast:12 row_mask:0xf bank_mask:0xf
v_dot2c_f32_bf16_dpp v41, v55, v112 row_newbcast:12 row_mask:0xf bank_mask:0xf
v_dot2c_f32_bf16_dpp v42, v53, v113 row_newbcast:12 row_mask:0xf bank_mask:0xf
v_dot2c_f32_bf16_dpp v43, v55, v113 row_newbcast:12 row_mask:0xf bank_mask:0xf
v_dot2c_f32_bf16_dpp v44, v53, v114 row_newbcast:12 row_mask:0xf bank_mask:0xf
v_dot2c_f32_bf16_dpp v45, v55, v114 row_newbcast:12 row_mask:0xf bank_mask:0xf
v_dot2c_f32_bf16_dpp v46, v53, v115 row_newbcast:12 row_mask:0xf bank_mask:0xf
v_dot2c_f32_bf16_dpp v47, v55, v115 row_newbcast:12 row_mask:0xf bank_mask:0xf
v_dot2c_f32_bf16_dpp v32, v52, v116 row_newbcast:13 row_mask:0xf bank_mask:0xf
v_dot2c_f32_bf16_dpp v33, v54, v116 row_newbcast:13 row_mask:0xf bank_mask:0xf
v_dot2c_f32_bf16_dpp v34, v52, v117 row_newbcast:13 row_mask:0xf bank_mask:0xf
v_dot2c_f32_bf16_dpp v35, v54, v117 row_newbcast:13 row_mask:0xf bank_mask:0xf
v_dot2c_f32_bf16_dpp v36, v52, v118 row_newbcast:13 row_mask:0xf bank_mask:0xf
v_dot2c_f32_bf16_dpp v37, v54, v118 row_newbcast:13 row_mask:0xf bank_mask:0xf
v_dot2c_f32_bf16_dpp v38, v52, v119 row_newbcast:13 row_mask:0xf bank_mask:0xf
v_dot2c_f32_bf16_dpp v39, v54, v119 row_newbcast:13 row_mask:0xf bank_mask:0xf
v_dot2c_f32_bf16_dpp v40, v53, v116 row_newbcast:13 row_mask:0xf bank_mask:0xf
v_dot2c_f32_bf16_dpp v41, v55, v116 row_newbcast:13 row_mask:0xf bank_mask:0xf
v_dot2c_f32_bf16_dpp v42, v53, v117 row_newbcast:13 row_mask:0xf bank_mask:0xf
v_dot2c_f32_bf16_dpp v43, v55, v117 row_newbcast:13 row_mask:0xf bank_mask:0xf
v_dot2c_f32_bf16_dpp v44, v53, v118 row_newbcast:13 row_mask:0xf bank_mask:0xf
v_dot2c_f32_bf16_dpp v45, v55, v118 row_newbcast:13 row_mask:0xf bank_mask:0xf
v_dot2c_f32_bf16_dpp v46, v53, v119 row_newbcast:13 row_mask:0xf bank_mask:0xf
v_dot2c_f32_bf16_dpp v47, v55, v119 row_newbcast:13 row_mask:0xf bank_mask:0xf
v_dot2c_f32_bf16_dpp v32, v52, v120 row_newbcast:14 row_mask:0xf bank_mask:0xf
v_dot2c_f32_bf16_dpp v33, v54, v120 row_newbcast:14 row_mask:0xf bank_mask:0xf
v_dot2c_f32_bf16_dpp v34, v52, v121 row_newbcast:14 row_mask:0xf bank_mask:0xf
v_dot2c_f32_bf16_dpp v35, v54, v121 row_newbcast:14 row_mask:0xf bank_mask:0xf
v_dot2c_f32_bf16_dpp v36, v52, v122 row_newbcast:14 row_mask:0xf bank_mask:0xf
v_dot2c_f32_bf16_dpp v37, v54, v122 row_newbcast:14 row_mask:0xf bank_mask:0xf
v_dot2c_f32_bf16_dpp v38, v52, v123 row_newbcast:14 row_mask:0xf bank_mask:0xf
v_dot2c_f32_bf16_dpp v39, v54, v123 row_newbcast:14 row_mask:0xf bank_mask:0xf
v_dot2c_f32_bf16_dpp v40, v53, v120 row_newbcast:14 row_mask:0xf bank_mask:0xf
v_dot2c_f32_bf16_dpp v41, v55, v120 row_newbcast:14 row_mask:0xf bank_mask:0xf
v_dot2c_f32_bf16_dpp v42, v53, v121 row_newbcast:14 row_mask:0xf bank_mask:0xf
v_dot2c_f32_bf16_dpp v43, v55, v121 row_newbcast:14 row_mask:0xf bank_mask:0xf
v_dot2c_f32_bf16_dpp v44, v53, v122 row_newbcast:14 row_mask:0xf bank_mask:0xf
v_dot2c_f32_bf16_dpp v45, v55, v122 row_newbcast:14 row_mask:0xf bank_mask:0xf
v_dot2c_f32_bf16_dpp v46, v53, v123 row_newbcast:14 row_mask:0xf bank_mask:0xf
v_dot2c_f32_bf16_dpp v47, v55, v123 row_newbcast:14 row_mask:0xf bank_mask:0xf
v_dot2c_f32_bf16_dpp v32, v52, v124 row_newbcast:15 row_mask:0xf bank_mask:0xf
v_dot2c_f32_bf16_dpp v33, v54, v124 row_newbcast:15 row_mask:0xf bank_mask:0xf
v_dot2c_f32_bf16_dpp v34, v52, v125 row_newbcast:15 row_mask:0xf bank_mask:0xf
v_dot2c_f32_bf16_dpp v35, v54, v125 row_newbcast:15 row_mask:0xf bank_mask:0xf
v_dot2c_f32_bf16_dpp v36, v52, v126 row_newbcast:15 row_mask:0xf bank_mask:0xf
v_dot2c_f32_bf16_dpp v37, v54, v126 row_newbcast:15 row_mask:0xf bank_mask:0xf
v_dot2c_f32_bf16_dpp v38, v52, v127 row_newbcast:15 row_mask:0xf bank_mask:0xf
v_dot2c_f32_bf16_dpp v39, v54, v127 row_newbcast:15 row_mask:0xf bank_mask:0xf
v_dot2c_f32_bf16_dpp v40, v53, v124 row_newbcast:15 row_mask:0xf bank_mask:0xf
v_dot2c_f32_bf16_dpp v41, v55, v124 row_newbcast:15 row_mask:0xf bank_mask:0xf
v_dot2c_f32_bf16_dpp v42, v53, v125 row_newbcast:15 row_mask:0xf bank_mask:0xf
v_dot2c_f32_bf16_dpp v43, v55, v125 row_newbcast:15 row_mask:0xf bank_mask:0xf
v_dot2c_f32_bf16_dpp v44, v53, v126 row_newbcast:15 row_mask:0xf bank_mask:0xf
v_dot2c_f32_bf16_dpp v45, v55, v126 row_newbcast:15 row_mask:0xf bank_mask:0xf
v_dot2c_f32_bf16_dpp v46, v53, v127 row_newbcast:15 row_mask:0xf bank_mask:0xf
v_dot2c_f32_bf16_dpp v47, v55, v127 row_newbcast:15 row_mask:0xf bank_mask:0xf
v_permlane32_swap_b32 v32, v33
v_permlane32_swap_b32 v34, v35
v_permlane32_swap_b32 v36, v37
v_permlane32_swap_b32 v38, v39
v_add_f32 v32, v32, v33
v_add_f32 v34, v34, v35
v_add_f32 v36, v36, v37
v_add_f32 v38, v38, v39
v_permlane16_swap_b32 v32, v34
s_nop 0
v_permlane16_swap_b32 v36, v38
v_add_f32 v32, v32, v34
v_add_f32 v36, v36, v38
v_permlane32_swap_b32 v40, v41
v_permlane32_swap_b32 v42, v43
v_permlane32_swap_b32 v44, v45
v_permlane32_swap_b32 v46, v47
v_add_f32 v40, v40, v41
v_add_f32 v42, v42, v43
v_add_f32 v44, v44, v45
v_add_f32 v46, v46, v47
v_permlane16_swap_b32 v40, v42
s_nop 0
v_permlane16_swap_b32 v44, v46
v_add_f32 v40, v40, v42
v_add_f32 v44, v44, v46
v_mov_b32 v16, v32
v_mov_b32 v17, v36
v_mov_b32 v18, s26
v_mov_b32 v19, s27
v_mov_b32 v20, v40
v_mov_b32 v21, v44
v_mov_b32 v22, s26
v_mov_b32 v23, s27
s_lshl_b32 s73, s68, 3
s_add_u32 s73, s73, s82
s_lshl_b32 s73, s73, 11
s_add_u32 s73, s73, 4096
s_mov_b32 s91, s73
buffer_store_dwordx4 v[16:19], v1, s[56:59], s91 offen
buffer_store_dwordx4 v[20:23], v1, s[56:59], s91 offen offset:1024
v_mov_b32 v100, 0
v_mov_b32 v101, 0
v_mov_b32 v102, 0
v_mov_b32 v103, 0
s_lshl_b32 s73, s68, 3
s_add_u32 s73, s73, s82
s_lshl_b32 s73, s73, 11
s_add_u32 s73, s73, 528384
buffer_store_dwordx4 v[100:103], v1, s[56:59], s73 offen
s_mov_b64 exec, 1
buffer_store_dwordx4 v[100:103], v1, s[56:59], s73 offen offset:1024
s_mov_b64 exec, -1
s_lshl_b32 s90, s68, 14
s_lshl_b32 s73, s69, 10
s_add_u32 s90, s90, s73
s_add_u32 s90, s90, 4096
s_mov_b64 s[28:29], -1
s_mov_b64 s[30:31], -1
s_mov_b64 s[32:33], -1
s_mov_b64 s[34:35], -1
s_mov_b64 s[44:45], -1
s_mov_b64 s[46:47], -1
s_mov_b64 s[48:49], -1
s_mov_b64 s[50:51], -1
s_mov_b64 s[60:61], -1
s_mov_b32 s62, 0
s_mov_b32 s96, 0
L_qg_25:
s_add_u32 s96, s96, 1
s_mov_b64 exec, s[28:29]
s_cbranch_execz L_sk_28
s_add_u32 s73, s90, 0
buffer_load_dwordx4 v[128:131], v1, s[56:59], s73 offen sc1
L_sk_28:
s_mov_b64 exec, s[30:31]
s_cbranch_execz L_sk_29
s_add_u32 s73, s90, 2048
buffer_load_dwordx4 v[132:135], v1, s[56:59], s73 offen sc1
L_sk_29:
s_mov_b64 exec, s[32:33]
s_cbranch_execz L_sk_30
s_add_u32 s73, s90, 4096
buffer_load_dwordx4 v[136:139], v1, s[56:59], s73 offen sc1
L_sk_30:
s_mov_b64 exec, s[34:35]
s_cbranch_execz L_sk_31
s_add_u32 s73, s90, 6144
buffer_load_dwordx4 v[140:143], v1, s[56:59], s73 offen sc1
L_sk_31:
s_mov_b64 exec, s[44:45]
s_cbranch_execz L_sk_32
s_add_u32 s73, s90, 8192
buffer_load_dwordx4 v[144:147], v1, s[56:59], s73 offen sc1
L_sk_32:
s_mov_b64 exec, s[46:47]
s_cbranch_execz L_sk_33
s_add_u32 s73, s90, 10240
buffer_load_dwordx4 v[148:151], v1, s[56:59], s73 offen sc1
L_sk_33:
s_mov_b64 exec, s[48:49]
s_cbranch_execz L_sk_34
s_add_u32 s73, s90, 12288
buffer_load_dwordx4 v[152:155], v1, s[56:59], s73 offen sc1
L_sk_34:
s_mov_b64 exec, s[50:51]
s_cbranch_execz L_sk_35
s_add_u32 s73, s90, 14336
buffer_load_dwordx4 v[156:159], v1, s[56:59], s73 offen sc1
L_sk_35:
s_mov_b64 exec, s[60:61]
s_cbranch_execz L_sk_36
buffer_load_dwordx4 v[160:163], v14, s[56:59], s93 offen sc1
L_sk_36:
s_mov_b64 exec, -1
s_waitcnt vmcnt(0)
v_cmp_ne_u32 vcc, s26, v130
v_cmp_ne_u32 s[98:99], s27, v131
s_nop 0
s_or_b64 vcc, vcc, s[98:99]
s_and_b64 s[28:29], s[28:29], vcc
s_mov_b64 s[94:95], s[28:29]
v_cmp_ne_u32 vcc, s26, v134
v_cmp_ne_u32 s[98:99], s27, v135
s_nop 0
s_or_b64 vcc, vcc, s[98:99]
s_and_b64 s[30:31], s[30:31], vcc
s_or_b64 s[94:95], s[94:95], s[30:31]
v_cmp_ne_u32 vcc, s26, v138
v_cmp_ne_u32 s[98:99], s27, v139
s_nop 0
s_or_b64 vcc, vcc, s[98:99]
s_and_b64 s[32:33], s[32:33], vcc
s_or_b64 s[94:95], s[94:95], s[32:33]
v_cmp_ne_u32 vcc, s26, v142
v_cmp_ne_u32 s[98:99], s27, v143
s_nop 0
s_or_b64 vcc, vcc, s[98:99]
s_and_b64 s[34:35], s[34:35], vcc
s_or_b64 s[94:95], s[94:95], s[34:35]
v_cmp_ne_u32 vcc, s26, v146
v_cmp_ne_u32 s[98:99], s27, v147
s_nop 0
s_or_b64 vcc, vcc, s[98:99]
s_and_b64 s[44:45], s[44:45], vcc
s_or_b64 s[94:95], s[94:95], s[44:45]
v_cmp_ne_u32 vcc, s26, v150
v_cmp_ne_u32 s[98:99], s27, v151
s_nop 0
s_or_b64 vcc, vcc, s[98:99]
s_and_b64 s[46:47], s[46:47], vcc
s_or_b64 s[94:95], s[94:95], s[46:47]
v_cmp_ne_u32 vcc, s26, v154
v_cmp_ne_u32 s[98:99], s27, v155
s_nop 0
s_or_b64 vcc, vcc, s[98:99]
s_and_b64 s[48:49], s[48:49], vcc
s_or_b64 s[94:95], s[94:95], s[48:49]
v_cmp_ne_u32 vcc, s26, v158
v_cmp_ne_u32 s[98:99], s27, v159
s_nop 0
s_or_b64 vcc, vcc, s[98:99]
s_and_b64 s[50:51], s[50:51], vcc
s_or_b64 s[94:95], s[94:95], s[50:51]
v_cmp_ne_u32 vcc, s26, v162
v_cmp_ne_u32 s[98:99], s27, v163
s_nop 0
s_or_b64 vcc, vcc, s[98:99]
s_and_b64 s[60:61], s[60:61], vcc
s_or_b64 s[94:95], s[94:95], s[60:61]
s_cmp_lg_u32 s62, 0
s_cbranch_scc1 L_qgnx_27
s_cmp_eq_u64 s[60:61], 0
s_cbranch_scc0 L_qgnx_27
s_mov_b32 s62, 1
v_cmp_ne_u32 vcc, s25, v160
s_nop 0
s_cmp_eq_u64 vcc, 0
s_cselect_b32 s25, 1, 0
s_cmp_lg_u32 s25, 0
s_cbranch_scc1 L_qfast_37
buffer_store_dwordx4 v[16:19], v1, s[56:59], s91 offen sc1
buffer_store_dwordx4 v[20:23], v1, s[56:59], s91 offen offset:1024 sc1
s_branch L_qgnx_27
L_qfast_37:
s_and_b32 s73, s68, 7
s_lshl_b32 s73, s73, 13
s_lshr_b32 s74, s68, 3
s_lshl_b32 s74, s74, 3
s_add_u32 s74, s74, s82
s_lshl_b32 s74, s74, 8
s_add_u32 s73, s73, s74
s_add_u32 s73, s73, 2097152
s_mov_b64 exec, 0xffff
buffer_store_dwordx4 v[100:103], v1, s[56:59], s73 offen
s_mov_b64 exec, -1
s_waitcnt vmcnt(0)
L_qgnx_27:
s_cmp_eq_u64 s[94:95], 0
s_cbranch_scc1 L_qgok_26
s_cmp_lt_u32 s96, 1048576
s_cbranch_scc1 L_qg_25
L_qgok_26:
v_mov_b32 v12, 312
v_mov_b32 v13, s25
ds_write_b32 v12, v13
v_add_f32 v128, v128, v132
v_add_f32 v136, v136, v140
v_add_f32 v144, v144, v148
v_add_f32 v152, v152, v156
v_add_f32 v128, v128, v136
v_add_f32 v144, v144, v152
v_add_f32 v128, v128, v144
v_add_f32 v129, v129, v133
v_add_f32 v137, v137, v141
v_add_f32 v145, v145, v149
v_add_f32 v153, v153, v157
v_add_f32 v129, v129, v137
v_add_f32 v145, v145, v153
v_add_f32 v129, v129, v145
v_cvt_pk_bf16_f32 v128, v128, v129
v_and_b32 v12, 1, v7
v_lshlrev_b32 v12, 1, v12
v_lshrrev_b32 v13, 1, v7
v_or_b32 v12, v12, v13
v_lshl_add_u32 v12, v6, 3, v12
v_lshlrev_b32 v12, 1, v12
ds_write_b16 v12, v128 offset:0
ds_write_b16_d16_hi v12, v128 offset:8
s_waitcnt lgkmcnt(0)
v_mov_b32 v12, 264
v_mov_b32 v13, 1
ds_write_b32 v12, v13
s_setprio 0
s_waitcnt vmcnt(0)
s_mov_b32 s40, s12
s_mov_b32 s41, s13
s_mov_b32 s42, 4194304
s_mov_b32 s43, 0x20000
s_mov_b32 s64, s22
s_mov_b32 s65, s23
s_mov_b32 s66, 256
s_mov_b32 s67, 0x20000
s_lshl_b32 s90, s68, 14
s_add_u32 s90, s90, 528384
v_lshlrev_b32 v14, 3, v0
v_and_b32 v3, 1, v6
v_mul_u32_u24 v3, 288, v3
v_lshl_add_u32 v3, v7, 3, v3
s_mul_i32 s73, s69, 288
s_add_u32 s73, s73, 608
v_lshlrev_b32 v4, 2, v0
v_add_u32 v52, s73, v4
s_xor_b32 s73, s69, 1
s_mul_i32 s73, s73, 288
s_add_u32 s73, s73, 608
v_add_u32 v53, s73, v4
v_and_b32 v5, 7, v6
v_xor_b32 v5, s82, v5
v_lshlrev_b32 v5, 11, v5
v_mov_b32 v18, s26
v_mov_b32 v19, s27
v_mov_b32 v22, s26
v_mov_b32 v23, s27
v_lshrrev_b32 v12, 1, v6
v_add_u32 v13, 0, v7
v_xor_b32 v12, v12, v13
v_lshlrev_b32 v12, 5, v12
v_and_b32 v13, 1, v6
v_lshl_add_u32 v12, v13, 4, v12
v_lshl_add_u32 v54, v7, 10, v12
v_lshrrev_b32 v12, 1, v6
v_add_u32 v13, 4, v7
v_xor_b32 v12, v12, v13
v_lshlrev_b32 v12, 5, v12
v_and_b32 v13, 1, v6
v_lshl_add_u32 v12, v13, 4, v12
v_lshl_add_u32 v55, v7, 10, v12
v_lshrrev_b32 v12, 2, v6
v_lshl_add_u32 v12, v7, 2, v12
v_and_b32 v4, 7, v12
v_lshlrev_b32 v12, 8, v12
v_and_b32 v13, 3, v0
v_lshl_add_u32 v12, v13, 3, v12
v_add_u32 v12, 23296, v12
v_xor_b32 v13, 0, v4
v_lshl_add_u32 v44, v13, 5, v12
v_xor_b32 v13, 1, v4
v_lshl_add_u32 v45, v13, 5, v12
v_xor_b32 v13, 2, v4
v_lshl_add_u32 v46, v13, 5, v12
v_xor_b32 v13, 3, v4
v_lshl_add_u32 v47, v13, 5, v12
v_xor_b32 v13, 4, v4
v_lshl_add_u32 v48, v13, 5, v12
v_xor_b32 v13, 5, v4
v_lshl_add_u32 v49, v13, 5, v12
v_xor_b32 v13, 6, v4
v_lshl_add_u32 v50, v13, 5, v12
v_xor_b32 v13, 7, v4
v_lshl_add_u32 v51, v13, 5, v12
v_mov_b32 v12, 308
s_mov_b32 s96, 0
L_trg_38:
ds_read_b32 v4, v12
s_add_u32 s96, s96, 1
s_waitcnt lgkmcnt(0)
v_readfirstlane_b32 s73, v4
s_nop 0
s_cmp_lg_u32 s73, 0
s_cbranch_scc1 L_trg2_39
s_sleep 2
s_cmp_lt_u32 s96, 67108864
s_cbranch_scc1 L_trg_38
L_trg2_39:
s_setprio 3
s_lshl_b32 s73, s68, 2
v_mov_b32 v4, 1
v_mov_b32 v13, s73
s_mov_b64 exec, 1
buffer_atomic_add v4, v13, s[64:67], 0 offen sc0
s_mov_b64 exec, -1
s_waitcnt vmcnt(0)
v_readfirstlane_b32 s33, v4
s_nop 0
s_and_b32 s33, s33, 7
s_add_u32 s73, s33, 1
v_mov_b32 v13, 316
v_mov_b32 v4, s73
ds_write_b32 v13, v4
s_lshl_b32 s83, s68, 2
s_add_u32 s83, s83, s33
s_cmp_ge_u32 s33, 4
s_cbranch_scc1 L_hred
v_mov_b32 v12, 308
s_mov_b32 s96, 0
L_trg3_40:
ds_read_b32 v4, v12
s_add_u32 s96, s96, 1
s_waitcnt lgkmcnt(0)
v_readfirstlane_b32 s73, v4
s_nop 0
s_cmp_ge_u32 s73, 2
s_cbranch_scc1 L_trg4_41
s_sleep 2
s_cmp_lt_u32 s96, 67108864
s_cbranch_scc1 L_trg3_40
L_trg4_41:
s_lshl_b32 s35, s68, 17
s_lshl_b32 s73, s33, 8
s_add_u32 s35, s35, s73
s_mov_b32 m0, 23296
s_add_u32 s73, s35, 0
buffer_load_dwordx4 v54, s[40:43], s73 offen lds
s_mov_b32 m0, 24320
s_add_u32 s73, s35, 4096
buffer_load_dwordx4 v55, s[40:43], s73 offen lds
s_mov_b32 m0, 25344
s_add_u32 s73, s35, 8192
buffer_load_dwordx4 v54, s[40:43], s73 offen lds
s_mov_b32 m0, 26368
s_add_u32 s73, s35, 12288
buffer_load_dwordx4 v55, s[40:43], s73 offen lds
s_mov_b32 m0, 27392
s_add_u32 s73, s35, 16384
buffer_load_dwordx4 v54, s[40:43], s73 offen lds
s_mov_b32 m0, 28416
s_add_u32 s73, s35, 20480
buffer_load_dwordx4 v55, s[40:43], s73 offen lds
s_mov_b32 m0, 29440
s_add_u32 s73, s35, 24576
buffer_load_dwordx4 v54, s[40:43], s73 offen lds
s_mov_b32 m0, 30464
s_add_u32 s73, s35, 28672
buffer_load_dwordx4 v55, s[40:43], s73 offen lds
s_mov_b32 m0, 31488
s_add_u32 s73, s35, 32768
buffer_load_dwordx4 v54, s[40:43], s73 offen lds
s_mov_b32 m0, 32512
s_add_u32 s73, s35, 36864
buffer_load_dwordx4 v55, s[40:43], s73 offen lds
s_mov_b32 m0, 33536
s_add_u32 s73, s35, 40960
buffer_load_dwordx4 v54, s[40:43], s73 offen lds
s_mov_b32 m0, 34560
s_add_u32 s73, s35, 45056
buffer_load_dwordx4 v55, s[40:43], s73 offen lds
s_mov_b32 m0, 35584
s_add_u32 s73, s35, 49152
buffer_load_dwordx4 v54, s[40:43], s73 offen lds
s_mov_b32 m0, 36608
s_add_u32 s73, s35, 53248
buffer_load_dwordx4 v55, s[40:43], s73 offen lds
s_mov_b32 m0, 37632
s_add_u32 s73, s35, 57344
buffer_load_dwordx4 v54, s[40:43], s73 offen lds
s_mov_b32 m0, 38656
s_add_u32 s73, s35, 61440
buffer_load_dwordx4 v55, s[40:43], s73 offen lds
s_mov_b32 m0, 39680
s_add_u32 s73, s35, 65536
buffer_load_dwordx4 v54, s[40:43], s73 offen lds
s_mov_b32 m0, 40704
s_add_u32 s73, s35, 69632
buffer_load_dwordx4 v55, s[40:43], s73 offen lds
s_mov_b32 m0, 41728
s_add_u32 s73, s35, 73728
buffer_load_dwordx4 v54, s[40:43], s73 offen lds
s_mov_b32 m0, 42752
s_add_u32 s73, s35, 77824
buffer_load_dwordx4 v55, s[40:43], s73 offen lds
s_mov_b32 m0, 43776
s_add_u32 s73, s35, 81920
buffer_load_dwordx4 v54, s[40:43], s73 offen lds
s_mov_b32 m0, 44800
s_add_u32 s73, s35, 86016
buffer_load_dwordx4 v55, s[40:43], s73 offen lds
s_mov_b32 m0, 45824
s_add_u32 s73, s35, 90112
buffer_load_dwordx4 v54, s[40:43], s73 offen lds
s_mov_b32 m0, 46848
s_add_u32 s73, s35, 94208
buffer_load_dwordx4 v55, s[40:43], s73 offen lds
s_mov_b32 m0, 47872
s_add_u32 s73, s35, 98304
buffer_load_dwordx4 v54, s[40:43], s73 offen lds
s_mov_b32 m0, 48896
s_add_u32 s73, s35, 102400
buffer_load_dwordx4 v55, s[40:43], s73 offen lds
s_mov_b32 m0, 49920
s_add_u32 s73, s35, 106496
buffer_load_dwordx4 v54, s[40:43], s73 offen lds
s_mov_b32 m0, 50944
s_add_u32 s73, s35, 110592
buffer_load_dwordx4 v55, s[40:43], s73 offen lds
s_mov_b32 m0, 51968
s_add_u32 s73, s35, 114688
buffer_load_dwordx4 v54, s[40:43], s73 offen lds
s_mov_b32 m0, 52992
s_add_u32 s73, s35, 118784
buffer_load_dwordx4 v55, s[40:43], s73 offen lds
s_mov_b32 m0, 54016
s_add_u32 s73, s35, 122880
buffer_load_dwordx4 v54, s[40:43], s73 offen lds
s_mov_b32 m0, 55040
s_add_u32 s73, s35, 126976
buffer_load_dwordx4 v55, s[40:43], s73 offen lds
s_lshl_b32 s92, s68, 13
s_lshl_b32 s73, s33, 11
s_add_u32 s92, s92, s73
s_add_u32 s92, s92, 1052672
v_mov_b32 v12, 304
v_mov_b32 v13, 6656
s_waitcnt vmcnt(0)
ds_read_b64_tr_b16 v[128:129], v44 offset:0
ds_read_b64_tr_b16 v[130:131], v44 offset:4096
ds_read_b64_tr_b16 v[132:133], v45 offset:0
ds_read_b64_tr_b16 v[134:135], v45 offset:4096
ds_read_b64_tr_b16 v[136:137], v46 offset:0
ds_read_b64_tr_b16 v[138:139], v46 offset:4096
ds_read_b64_tr_b16 v[140:141], v47 offset:0
ds_read_b64_tr_b16 v[142:143], v47 offset:4096
ds_read_b64_tr_b16 v[144:145], v48 offset:0
ds_read_b64_tr_b16 v[146:147], v48 offset:4096
ds_read_b64_tr_b16 v[148:149], v49 offset:0
ds_read_b64_tr_b16 v[150:151], v49 offset:4096
ds_read_b64_tr_b16 v[152:153], v50 offset:0
ds_read_b64_tr_b16 v[154:155], v50 offset:4096
ds_read_b64_tr_b16 v[156:157], v51 offset:0
ds_read_b64_tr_b16 v[158:159], v51 offset:4096
ds_read_b64_tr_b16 v[160:161], v44 offset:8192
ds_read_b64_tr_b16 v[162:163], v44 offset:12288
ds_read_b64_tr_b16 v[164:165], v45 offset:8192
ds_read_b64_tr_b16 v[166:167], v45 offset:12288
ds_read_b64_tr_b16 v[168:169], v46 offset:8192
ds_read_b64_tr_b16 v[170:171], v46 offset:12288
ds_read_b64_tr_b16 v[172:173], v47 offset:8192
ds_read_b64_tr_b16 v[174:175], v47 offset:12288
ds_read_b64_tr_b16 v[176:177], v48 offset:8192
ds_read_b64_tr_b16 v[178:179], v48 offset:12288
ds_read_b64_tr_b16 v[180:181], v49 offset:8192
ds_read_b64_tr_b16 v[182:183], v49 offset:12288
ds_read_b64_tr_b16 v[184:185], v50 offset:8192
ds_read_b64_tr_b16 v[186:187], v50 offset:12288
ds_read_b64_tr_b16 v[188:189], v51 offset:8192
ds_read_b64_tr_b16 v[190:191], v51 offset:12288
ds_read_b64_tr_b16 v[192:193], v44 offset:16384
ds_read_b64_tr_b16 v[194:195], v44 offset:20480
ds_read_b64_tr_b16 v[196:197], v45 offset:16384
ds_read_b64_tr_b16 v[198:199], v45 offset:20480
ds_read_b64_tr_b16 v[200:201], v46 offset:16384
ds_read_b64_tr_b16 v[202:203], v46 offset:20480
ds_read_b64_tr_b16 v[204:205], v47 offset:16384
ds_read_b64_tr_b16 v[206:207], v47 offset:20480
ds_read_b64_tr_b16 v[208:209], v48 offset:16384
ds_read_b64_tr_b16 v[210:211], v48 offset:20480
ds_read_b64_tr_b16 v[212:213], v49 offset:16384
ds_read_b64_tr_b16 v[214:215], v49 offset:20480
ds_read_b64_tr_b16 v[216:217], v50 offset:16384
ds_read_b64_tr_b16 v[218:219], v50 offset:20480
ds_read_b64_tr_b16 v[220:221], v51 offset:16384
ds_read_b64_tr_b16 v[222:223], v51 offset:20480
ds_read_b64_tr_b16 v[224:225], v44 offset:24576
ds_read_b64_tr_b16 v[226:227], v44 offset:28672
ds_read_b64_tr_b16 v[228:229], v45 offset:24576
ds_read_b64_tr_b16 v[230:231], v45 offset:28672
ds_read_b64_tr_b16 v[232:233], v46 offset:24576
ds_read_b64_tr_b16 v[234:235], v46 offset:28672
ds_read_b64_tr_b16 v[236:237], v47 offset:24576
ds_read_b64_tr_b16 v[238:239], v47 offset:28672
ds_read_b64_tr_b16 v[240:241], v48 offset:24576
ds_read_b64_tr_b16 v[242:243], v48 offset:28672
ds_read_b64_tr_b16 v[244:245], v49 offset:24576
ds_read_b64_tr_b16 v[246:247], v49 offset:28672
ds_read_b64_tr_b16 v[248:249], v50 offset:24576
ds_read_b64_tr_b16 v[250:251], v50 offset:28672
ds_read_b64_tr_b16 v[252:253], v51 offset:24576
ds_read_b64_tr_b16 v[254:255], v51 offset:28672
s_xor_b32 s73, s82, 1
s_lshl_b32 s73, s73, 11
s_add_u32 s45, s73, s90
s_xor_b32 s73, s82, 2
s_lshl_b32 s73, s73, 11
s_add_u32 s46, s73, s90
s_xor_b32 s73, s82, 3
s_lshl_b32 s73, s73, 11
s_add_u32 s47, s73, s90
s_xor_b32 s73, s82, 4
s_lshl_b32 s73, s73, 11
s_add_u32 s48, s73, s90
s_xor_b32 s73, s82, 5
s_lshl_b32 s73, s73, 11
s_add_u32 s49, s73, s90
s_xor_b32 s73, s82, 6
s_lshl_b32 s73, s73, 11
s_add_u32 s50, s73, s90
s_xor_b32 s73, s82, 7
s_lshl_b32 s73, s73, 11
s_add_u32 s51, s73, s90
s_mov_b32 s42, 0x01010101
s_mov_b32 s43, 0x01010101
s_mov_b32 s96, 0
L_own_42:
ds_read_b32 v4, v12
s_add_u32 s96, s96, 1
s_waitcnt lgkmcnt(0)
v_readfirstlane_b32 s32, v4
s_nop 0
s_cmp_lg_u32 s32, 0
s_cbranch_scc1 L_own2_43
s_sleep 1
s_cmp_lt_u32 s96, 67108864
s_cbranch_scc1 L_own_42
L_own2_43:
s_mov_b32 s96, 0
ds_read_b64 v[64:65], v14 offset:6144
ds_read_b64 v[100:101], v13
L_og_44:
s_add_u32 s96, s96, 1
buffer_load_dwordx4 v[96:99], v5, s[56:59], s90 offen offset:1024 sc1
buffer_load_dwordx4 v[68:71], v1, s[56:59], s45 offen sc1
buffer_load_dwordx4 v[72:75], v1, s[56:59], s46 offen sc1
buffer_load_dwordx4 v[76:79], v1, s[56:59], s47 offen sc1
buffer_load_dwordx4 v[80:83], v1, s[56:59], s48 offen sc1
buffer_load_dwordx4 v[84:87], v1, s[56:59], s49 offen sc1
buffer_load_dwordx4 v[88:91], v1, s[56:59], s50 offen sc1
buffer_load_dwordx4 v[92:95], v1, s[56:59], s51 offen sc1
s_waitcnt vmcnt(0)
v_xor_b32 v25, s26, v98
v_xor_b32 v26, s27, v99
v_or_b32 v24, v25, v26
v_cndmask_b32 v24, v24, 0, s[42:43]
v_xor_b32 v25, s26, v70
v_xor_b32 v26, s27, v71
v_or3_b32 v24, v24, v25, v26
v_xor_b32 v25, s26, v74
v_xor_b32 v26, s27, v75
v_or3_b32 v24, v24, v25, v26
v_xor_b32 v25, s26, v78
v_xor_b32 v26, s27, v79
v_or3_b32 v24, v24, v25, v26
v_xor_b32 v25, s26, v82
v_xor_b32 v26, s27, v83
v_or3_b32 v24, v24, v25, v26
v_xor_b32 v25, s26, v86
v_xor_b32 v26, s27, v87
v_or3_b32 v24, v24, v25, v26
v_xor_b32 v25, s26, v90
v_xor_b32 v26, s27, v91
v_or3_b32 v24, v24, v25, v26
v_xor_b32 v25, s26, v94
v_xor_b32 v26, s27, v95
v_or3_b32 v24, v24, v25, v26
v_cmp_ne_u32 vcc, 0, v24
s_nop 0
s_cmp_eq_u64 vcc, 0
s_cbranch_scc1 L_ogok_45
s_cmp_lt_u32 s96, 1048576
s_cbranch_scc1 L_og_44
L_ogok_45:
s_waitcnt lgkmcnt(0)
v_cndmask_b32 v96, v96, v100, s[42:43]
v_cndmask_b32 v97, v97, v101, s[42:43]
s_nop 0
v_max_f32_dpp v24, v96, v96 quad_perm:[1,0,3,2] row_mask:0xf bank_mask:0xf
s_nop 1
v_max_f32_dpp v24, v24, v24 quad_perm:[2,3,0,1] row_mask:0xf bank_mask:0xf
v_sub_f32 v24, v96, v24
v_mul_f32 v24, 0x3fb8aa3b, v24
v_exp_f32 v24, v24
s_nop 0
v_mul_f32 v25, v24, v97
s_nop 1
v_add_f32_dpp v25, v25, v25 quad_perm:[1,0,3,2] row_mask:0xf bank_mask:0xf
s_nop 1
v_add_f32_dpp v25, v25, v25 quad_perm:[2,3,0,1] row_mask:0xf bank_mask:0xf
v_rcp_f32 v25, v25
s_nop 0
v_mul_f32 v24, v24, v25
s_nop 0
v_readlane_b32 s60, v24, 0
v_readlane_b32 s61, v24, 1
v_readlane_b32 s62, v24, 2
v_readlane_b32 s63, v24, 3
v_readlane_b32 s64, v24, 4
v_readlane_b32 s65, v24, 5
v_readlane_b32 s66, v24, 6
v_readlane_b32 s67, v24, 7
v_mul_f32 v26, s60, v64
v_mul_f32 v27, s60, v65
v_mul_f32 v28, s64, v80
v_mul_f32 v29, s64, v81
v_fma_f32 v26, s61, v68, v26
v_fma_f32 v27, s61, v69, v27
v_fma_f32 v28, s65, v84, v28
v_fma_f32 v29, s65, v85, v29
v_fma_f32 v26, s62, v72, v26
v_fma_f32 v27, s62, v73, v27
v_fma_f32 v28, s66, v88, v28
v_fma_f32 v29, s66, v89, v29
v_fma_f32 v26, s63, v76, v26
v_fma_f32 v27, s63, v77, v27
v_fma_f32 v28, s67, v92, v28
v_fma_f32 v29, s67, v93, v29
v_cvt_pk_bf16_f32 v26, v26, v27
ds_write_b32 v52, v26
v_cvt_pk_bf16_f32 v28, v28, v29
ds_write_b32 v53, v28
ds_read2_b64 v[104:107], v3 offset0:76 offset1:80
ds_read2_b64 v[108:111], v3 offset0:84 offset1:88
ds_read2_b64 v[112:115], v3 offset0:92 offset1:96
ds_read2_b64 v[116:119], v3 offset0:100 offset1:104
s_waitcnt lgkmcnt(3)
v_mfma_f32_16x16x32_bf16 v[32:35], v[104:107], v[128:131], 0
v_mfma_f32_16x16x32_bf16 v[36:39], v[104:107], v[132:135], 0
v_mfma_f32_16x16x32_bf16 v[40:43], v[104:107], v[136:139], 0
v_mfma_f32_16x16x32_bf16 v[44:47], v[104:107], v[140:143], 0
v_mfma_f32_16x16x32_bf16 v[48:51], v[104:107], v[144:147], 0
v_mfma_f32_16x16x32_bf16 v[52:55], v[104:107], v[148:151], 0
v_mfma_f32_16x16x32_bf16 v[56:59], v[104:107], v[152:155], 0
v_mfma_f32_16x16x32_bf16 v[60:63], v[104:107], v[156:159], 0
s_waitcnt lgkmcnt(2)
v_mfma_f32_16x16x32_bf16 v[32:35], v[108:111], v[160:163], v[32:35]
v_mfma_f32_16x16x32_bf16 v[36:39], v[108:111], v[164:167], v[36:39]
v_mfma_f32_16x16x32_bf16 v[40:43], v[108:111], v[168:171], v[40:43]
v_mfma_f32_16x16x32_bf16 v[44:47], v[108:111], v[172:175], v[44:47]
v_mfma_f32_16x16x32_bf16 v[48:51], v[108:111], v[176:179], v[48:51]
v_mfma_f32_16x16x32_bf16 v[52:55], v[108:111], v[180:183], v[52:55]
v_mfma_f32_16x16x32_bf16 v[56:59], v[108:111], v[184:187], v[56:59]
v_mfma_f32_16x16x32_bf16 v[60:63], v[108:111], v[188:191], v[60:63]
s_waitcnt lgkmcnt(1)
v_mfma_f32_16x16x32_bf16 v[32:35], v[112:115], v[192:195], v[32:35]
v_mfma_f32_16x16x32_bf16 v[36:39], v[112:115], v[196:199], v[36:39]
v_mfma_f32_16x16x32_bf16 v[40:43], v[112:115], v[200:203], v[40:43]
v_mfma_f32_16x16x32_bf16 v[44:47], v[112:115], v[204:207], v[44:47]
v_mfma_f32_16x16x32_bf16 v[48:51], v[112:115], v[208:211], v[48:51]
v_mfma_f32_16x16x32_bf16 v[52:55], v[112:115], v[212:215], v[52:55]
v_mfma_f32_16x16x32_bf16 v[56:59], v[112:115], v[216:219], v[56:59]
v_mfma_f32_16x16x32_bf16 v[60:63], v[112:115], v[220:223], v[60:63]
s_waitcnt lgkmcnt(0)
v_mfma_f32_16x16x32_bf16 v[32:35], v[116:119], v[224:227], v[32:35]
v_mfma_f32_16x16x32_bf16 v[36:39], v[116:119], v[228:231], v[36:39]
v_mfma_f32_16x16x32_bf16 v[40:43], v[116:119], v[232:235], v[40:43]
v_mfma_f32_16x16x32_bf16 v[44:47], v[116:119], v[236:239], v[44:47]
v_mfma_f32_16x16x32_bf16 v[48:51], v[116:119], v[240:243], v[48:51]
v_mfma_f32_16x16x32_bf16 v[52:55], v[116:119], v[244:247], v[52:55]
v_mfma_f32_16x16x32_bf16 v[56:59], v[116:119], v[248:251], v[56:59]
v_mfma_f32_16x16x32_bf16 v[60:63], v[116:119], v[252:255], v[60:63]
s_nop 1
v_cndmask_b32 v16, v32, v36, s[84:85]
v_cndmask_b32 v16, v16, v40, s[86:87]
v_cndmask_b32 v16, v16, v44, s[88:89]
v_cndmask_b32 v17, v33, v37, s[84:85]
v_cndmask_b32 v17, v17, v41, s[86:87]
v_cndmask_b32 v17, v17, v45, s[88:89]
buffer_store_dwordx4 v[16:19], v1, s[56:59], s92 offen offset:0 sc1
v_cndmask_b32 v20, v48, v52, s[84:85]
v_cndmask_b32 v20, v20, v56, s[86:87]
v_cndmask_b32 v20, v20, v60, s[88:89]
v_cndmask_b32 v21, v49, v53, s[84:85]
v_cndmask_b32 v21, v21, v57, s[86:87]
v_cndmask_b32 v21, v21, v61, s[88:89]
buffer_store_dwordx4 v[20:23], v1, s[56:59], s92 offen offset:1024 sc1
v_mov_b32 v12, 592
v_mov_b32 v13, 1
ds_write_b32 v12, v13
s_mov_b32 s60, s20
s_mov_b32 s61, s21
s_mov_b32 s62, 2048
s_mov_b32 s63, 0x20000
v_and_b32 v12, 3, v0
v_lshlrev_b32 v14, 1, v12
s_lshl_b32 s90, s83, 3
v_lshrrev_b32 v2, 2, v0
v_lshlrev_b32 v2, 13, v2
v_lshl_add_u32 v2, v12, 4, v2
s_lshl_b32 s37, s83, 6
s_and_b32 s36, s68, 7
s_lshl_b32 s36, s36, 13
s_add_u32 s36, s36, s37
s_add_u32 s36, s36, 2097152
s_add_u32 s37, s37, 1380352
v_lshlrev_b32 v3, 4, v12
s_mov_b64 s[28:29], -1
s_mov_b32 s96, 0
L_poll_46:
s_add_u32 s96, s96, 1
s_mov_b64 exec, s[28:29]
s_cbranch_execz L_sk_48
buffer_load_dwordx4 v[184:187], v3, s[56:59], s36 offen sc1
L_sk_48:
s_mov_b64 exec, -1
s_waitcnt vmcnt(0)
v_cmp_ne_u32 vcc, s26, v186
v_cmp_ne_u32 s[98:99], s27, v187
s_nop 0
s_or_b64 vcc, vcc, s[98:99]
s_and_b64 s[28:29], s[28:29], vcc
s_mov_b64 s[94:95], s[28:29]
s_cmp_eq_u64 s[94:95], 0
s_cbranch_scc1 L_pok_47
s_cmp_lt_u32 s96, 1048576
s_cbranch_scc1 L_poll_46
L_pok_47:
s_mov_b32 s92, 0xffffff
s_mov_b32 s93, 0x0
v_mov_b32 v84, 0
v_mov_b32 v85, 0
v_mov_b32 v86, 0
v_mov_b32 v87, 0
s_mov_b64 s[28:29], -1
s_mov_b64 s[30:31], -1
s_mov_b64 s[32:33], -1
s_mov_b64 s[34:35], -1
s_mov_b64 s[44:45], -1
s_mov_b64 s[46:47], s[92:93]
s_mov_b32 s96, 0
L_poll_49:
s_add_u32 s96, s96, 1
s_mov_b64 exec, s[28:29]
s_cbranch_execz L_sk_51
s_add_u32 s73, s37, 0
buffer_load_dwordx4 v[64:67], v2, s[56:59], s73 offen sc1
L_sk_51:
s_mov_b64 exec, s[30:31]
s_cbranch_execz L_sk_52
s_add_u32 s73, s37, 131072
buffer_load_dwordx4 v[68:71], v2, s[56:59], s73 offen sc1
L_sk_52:
s_mov_b64 exec, s[32:33]
s_cbranch_execz L_sk_53
s_add_u32 s73, s37, 262144
buffer_load_dwordx4 v[72:75], v2, s[56:59], s73 offen sc1
L_sk_53:
s_mov_b64 exec, s[34:35]
s_cbranch_execz L_sk_54
s_add_u32 s73, s37, 393216
buffer_load_dwordx4 v[76:79], v2, s[56:59], s73 offen sc1
L_sk_54:
s_mov_b64 exec, s[44:45]
s_cbranch_execz L_sk_55
s_add_u32 s73, s37, 524288
buffer_load_dwordx4 v[80:83], v2, s[56:59], s73 offen sc1
L_sk_55:
s_mov_b64 exec, s[46:47]
s_cbranch_execz L_sk_56
s_add_u32 s73, s37, 655360
buffer_load_dwordx4 v[84:87], v2, s[56:59], s73 offen sc1
L_sk_56:
s_mov_b64 exec, -1
s_waitcnt vmcnt(0)
v_cmp_ne_u32 vcc, s26, v66
v_cmp_ne_u32 s[98:99], s27, v67
s_nop 0
s_or_b64 vcc, vcc, s[98:99]
s_and_b64 s[28:29], s[28:29], vcc
s_mov_b64 s[94:95], s[28:29]
v_cmp_ne_u32 vcc, s26, v70
v_cmp_ne_u32 s[98:99], s27, v71
s_nop 0
s_or_b64 vcc, vcc, s[98:99]
s_and_b64 s[30:31], s[30:31], vcc
s_or_b64 s[94:95], s[94:95], s[30:31]
v_cmp_ne_u32 vcc, s26, v74
v_cmp_ne_u32 s[98:99], s27, v75
s_nop 0
s_or_b64 vcc, vcc, s[98:99]
s_and_b64 s[32:33], s[32:33], vcc
s_or_b64 s[94:95], s[94:95], s[32:33]
v_cmp_ne_u32 vcc, s26, v78
v_cmp_ne_u32 s[98:99], s27, v79
s_nop 0
s_or_b64 vcc, vcc, s[98:99]
s_and_b64 s[34:35], s[34:35], vcc
s_or_b64 s[94:95], s[94:95], s[34:35]
v_cmp_ne_u32 vcc, s26, v82
v_cmp_ne_u32 s[98:99], s27, v83
s_nop 0
s_or_b64 vcc, vcc, s[98:99]
s_and_b64 s[44:45], s[44:45], vcc
s_or_b64 s[94:95], s[94:95], s[44:45]
v_cmp_ne_u32 vcc, s26, v86
v_cmp_ne_u32 s[98:99], s27, v87
s_nop 0
s_or_b64 vcc, vcc, s[98:99]
s_and_b64 s[46:47], s[46:47], vcc
s_or_b64 s[94:95], s[94:95], s[46:47]
s_cmp_eq_u64 s[94:95], 0
s_cbranch_scc1 L_pok_50
s_cmp_lt_u32 s96, 1048576
s_cbranch_scc1 L_poll_49
L_pok_50:
v_add_f32 v24, v64, v68
v_add_f32 v25, v65, v69
v_add_f32 v24, v24, v72
v_add_f32 v25, v25, v73
v_add_f32 v24, v24, v76
v_add_f32 v25, v25, v77
v_add_f32 v24, v24, v80
v_add_f32 v25, v25, v81
v_add_f32 v24, v24, v84
v_add_f32 v25, v25, v85
s_nop 0
v_add_f32_dpp v24, v24, v24 row_ror:8 row_mask:0xf bank_mask:0xf
v_add_f32_dpp v25, v25, v25 row_ror:8 row_mask:0xf bank_mask:0xf
s_nop 0
v_add_f32_dpp v24, v24, v24 row_ror:4 row_mask:0xf bank_mask:0xf
v_add_f32_dpp v25, v25, v25 row_ror:4 row_mask:0xf bank_mask:0xf
v_mov_b32 v28, v24
v_mov_b32 v29, v25
s_nop 0
v_permlane16_swap_b32 v24, v28
v_permlane16_swap_b32 v25, v29
v_add_f32 v24, v24, v28
v_add_f32 v25, v25, v29
v_mov_b32 v28, v24
v_mov_b32 v29, v25
s_nop 0
v_permlane32_swap_b32 v24, v28
v_permlane32_swap_b32 v25, v29
v_add_f32 v24, v24, v28
v_add_f32 v25, v25, v29
v_cvt_pk_bf16_f32 v24, v24, v24
v_cvt_pk_bf16_f32 v25, v25, v25
v_and_b32 v24, 0xffff0000, v24
v_and_b32 v25, 0xffff0000, v25
v_add_f32 v24, v24, v184
v_add_f32 v25, v25, v185
v_cvt_pk_bf16_f32 v24, v24, v25
s_mov_b64 exec, 0xf
buffer_store_short v24, v14, s[60:63], s90 offen
buffer_store_short_d16_hi v24, v14, s[60:63], s90 offen offset:1024
s_cmp_lg_u32 s83, 0
s_cbranch_scc1 L_noep_57
s_mov_b64 exec, 1
v_mov_b32 v12, 0
buffer_store_dwordx2 v[186:187], v12, s[56:59], 0 offen sc1
L_noep_57:
s_mov_b64 exec, -1
L_hred:
s_endpgm
L_end:
s_endpgm
.section .rodata,"a"
.p2align 6
.amdhsa_kernel sequential_preLN__mha_block_cached__dense_activation_silu__decode_kernel
  .amdhsa_next_free_vgpr 256
  .amdhsa_next_free_sgpr 102
  .amdhsa_accum_offset 256
  .amdhsa_group_segment_fixed_size 0
  .amdhsa_kernarg_size 88
  .amdhsa_user_sgpr_count 2
  .amdhsa_user_sgpr_kernarg_segment_ptr 1
  .amdhsa_system_sgpr_workgroup_id_x 1
.end_amdhsa_kernel
```
